```python
import torch

def _softmax(x, axis=-1):
    return torch.softmax(x, dim=axis)
def _gelu(x):
    return torch.nn.functional.gelu(x, approximate="tanh")
def _silu(x):
    return torch.nn.functional.silu(x)
def _sigmoid(x):
    return torch.sigmoid(x)
def _layernorm(x, axis=-1, eps=1e-5):
    m = x.mean(dim=axis, keepdim=True)
    v = x.var(dim=axis, keepdim=True, unbiased=False)
    return (x - m) / torch.sqrt(v + eps)
def _scatter_add(tgt, idx, src, axis=0):
    return tgt.clone().index_add_(axis, idx, src)
def _segment_sum(src, seg, n):
    out = torch.zeros((n,) + src.shape[1:], dtype=src.dtype)
    return out.index_add_(0, seg, src)
def _pad(x, pw):
    flat = tuple(v for pair in reversed(pw) for v in pair)
    return torch.nn.functional.pad(x, flat)

kernel_name = 'interleave_layers__gqa_block_cached__glu_gated_swiglu__decode'

def setup_inputs():

    _w = (lambda a: (lambda t: t.to(torch.bfloat16) if t.is_floating_point() else t)(torch.as_tensor(a)))
    def _A_setup():
        B, Sq, D = 4, 1, 576
        Hq, Hkv, Sk, Dh = 32, 16, 4096, 128
        assert Hq % Hkv == 0, (Hq, Hkv)
        return {
            "x": _w((lambda *s: torch.randn(*s, dtype=torch.bfloat16) * 0.05)(B, Sq, D)),
            "k_cache": _w((lambda *s: torch.randn(*s, dtype=torch.bfloat16) * 0.8)(B, Hkv, Sk, Dh)),
            "v_cache": _w((lambda *s: torch.randn(*s, dtype=torch.bfloat16) * 0.8)(B, Hkv, Sk, Dh)),
            "wq": _w((lambda *s: torch.randn(*s, dtype=torch.bfloat16) * 0.8)(D, Hq * Dh) * (D ** -0.5)),
            "wo": _w((lambda *s: torch.randn(*s, dtype=torch.bfloat16) * 0.8)(Hq * Dh, D) * ((Hq * Dh) ** -0.5)),
        }
    _A_in = _A_setup()

    def _B_setup():
        B, S, D, F = 4, 1, 576, 4608
        return {
            "x": _w((lambda *s: torch.randn(*s, dtype=torch.bfloat16) * 0.05)(B, S, D)),
            "w1": _w((lambda *s: torch.randn(*s, dtype=torch.bfloat16) * 0.2)(D, F) * (2.0 / D) ** 0.5),
            "w3": _w((lambda *s: torch.randn(*s, dtype=torch.bfloat16) * 0.2)(D, F) * (2.0 / D) ** 0.5),
            "w2": _w((lambda *s: torch.randn(*s, dtype=torch.bfloat16) * 0.2)(F, D) * (2.0 / F) ** 0.5),
        }
    _B_in = _B_setup()

    return {
        "A_x": _A_in["x"],
        "A_k_cache": _A_in["k_cache"],
        "A_v_cache": _A_in["v_cache"],
        "A_wq": _A_in["wq"],
        "A_wo": _A_in["wo"],
        "B_x": _B_in["x"],
        "B_w1": _B_in["w1"],
        "B_w3": _B_in["w3"],
        "B_w2": _B_in["w2"],
    }

def reference(A_x, A_k_cache, A_v_cache, A_wq, A_wo, B_x, B_w1, B_w3, B_w2):
    def _A_ref(x, k_cache, v_cache, wq, wo):
        B, Sq, D = x.shape
        Hq, Dh = 32, 128
        Hkv = k_cache.shape[1]
        rep = Hq // Hkv
        q = (lambda x, *d: x.permute(*d))((x @ wq).reshape(B, Sq, Hq, Dh), 0, 2, 1, 3)
        k = (lambda x, n, axis: torch.repeat_interleave(x, n, dim=axis))(k_cache, rep, axis=1)
        v = (lambda x, n, axis: torch.repeat_interleave(x, n, dim=axis))(v_cache, rep, axis=1)
        scores = torch.einsum("bhqd,bhkd->bhqk", q, k) * (Dh ** -0.5)
        p = _softmax(scores, axis=-1)
        o = torch.einsum("bhqk,bhkd->bhqd", p, v)
        return (lambda x, *d: x.permute(*d))(o, 0, 2, 1, 3).reshape(B, Sq, Hq * Dh) @ wo

    def _B_ref(x, w1, w3, w2):
        gate = torch.einsum("bsd,df->bsf", x, w1)
        up = torch.einsum("bsd,df->bsf", x, w3)
        h = _silu(gate) * up
        out = torch.einsum("bsf,fd->bsd", h, w2)
        return out

    x = A_x
    x = x + _A_ref(_layernorm(x, axis=-1), A_k_cache, A_v_cache, A_wq, A_wo)
    x = x + _B_ref(_layernorm(x, axis=-1), B_w1, B_w3, B_w2)
    x = x + _A_ref(_layernorm(x, axis=-1), A_k_cache, A_v_cache, A_wq, A_wo)
    x = x + _B_ref(_layernorm(x, axis=-1), B_w1, B_w3, B_w2)
    return x
```

```asm
; @launch grid=(256,1,1) block=(256,1,1) lds=163840
.amdgcn_target "amdgcn-amd-amdhsa--gfx950"
.text
.globl interleave_layers__gqa_block_cached__glu_gated_swiglu__decode_kernel
.p2align 8
.type interleave_layers__gqa_block_cached__glu_gated_swiglu__decode_kernel,@function
interleave_layers__gqa_block_cached__glu_gated_swiglu__decode_kernel:
s_cmp_ge_u32 s2, 256
s_cbranch_scc1 L_end
s_load_dwordx16 s[80:95], s[0:1], 0
s_load_dwordx8 s[20:27], s[0:1], 64
s_getpc_b64 s[28:29]
L_pc0:
v_lshlrev_b32 v4, 7, v0
v_min_u32 v4, L_epi-L_pc0, v4
global_load_dword v126, v4, s[28:29]
v_lshrrev_b32 v1, 6, v0
v_and_b32 v0, 63, v0
v_readfirstlane_b32 s3, v1
s_and_b32 s4, s2, 7
s_lshr_b32 s5, s2, 3
s_lshr_b32 s9, s5, 4
s_bfe_u32 s10, s5, 0x20002
s_lshl_b32 s11, s10, 4
s_add_u32 s11, s11, s9
s_lshl_b32 s12, s4, 1
s_add_u32 s11, s11, s12
s_lshl_b32 s11, s11, 2
s_and_b32 s12, s5, 3
s_add_u32 s11, s11, s12
s_lshl_b32 s11, s11, 2
s_add_u32 s11, s11, s3
s_lshl_b32 s11, s11, 16
s_getreg_b32 s12, hwreg(HW_REG_XCC_ID, 0, 4)
s_lshl_b32 s100, s5, 2
s_add_u32 s100, s100, s3
s_mul_i32 s100, s100, 12288
v_lshrrev_b32 v64, 4, v0
v_and_b32 v65, 15, v0
v_xor_b32 v5, v65, v64
v_lshlrev_b32 v5, 4, v5
v_lshl_add_u32 v80, v64, 8, v5
v_xor_b32 v81, 64, v80
v_xor_b32 v82, 128, v80
v_xor_b32 v83, 192, v80
s_lshl_b32 s35, s3, 15
v_lshl_add_u32 v84, v65, 8, v5
v_add_u32 v84, s35, v84
v_xor_b32 v85, 64, v84
v_xor_b32 v86, 128, v84
v_xor_b32 v87, 192, v84
s_waitcnt lgkmcnt(0)
s_add_u32 s36, s82, s11
s_addc_u32 s37, s83, 0
s_and_b32 s37, s37, 0xffff
s_mov_b32 s38, 65536
s_mov_b32 s39, 0x20000
s_add_u32 s98, s35, 0
s_mov_b32 m0, s98
s_add_u32 s98, s100, 0
s_and_b32 s98, s98, 0xffff
buffer_load_dwordx4 v80, s[36:39], s98 offen offset:0 nt lds
buffer_load_dwordx4 v81, s[36:39], s98 offen offset:1024 nt lds
buffer_load_dwordx4 v82, s[36:39], s98 offen offset:2048 nt lds
buffer_load_dwordx4 v83, s[36:39], s98 offen offset:3072 nt lds
s_mov_b32 s44, s26
s_and_b32 s45, s27, 0xffff
s_mov_b32 s46, 3104768
s_mov_b32 s47, 0x20000
s_lshl_b32 s13, s4, 18
v_lshlrev_b32 v69, 4, v0
v_mov_b32 v76, -1
v_mov_b32 v77, -1
v_mov_b32 v78, -1
v_mov_b32 v79, -1
s_lshl_b32 s9, s5, 2
s_add_u32 s9, s9, s3
s_mul_i32 s9, s9, 320
s_add_u32 s9, s9, s13
s_lshl_b32 s10, s2, 2
s_add_u32 s10, s10, s3
s_mul_i32 s10, s10, 368
s_add_u32 s10, s10, 2097152
s_mov_b64 exec, 0xfffff
buffer_store_dwordx4 v[76:79], v69, s[44:47], s9 offen sc1
s_mov_b64 exec, 0x7fffff
buffer_store_dwordx4 v[76:79], v69, s[44:47], s10 offen sc1
s_sub_u32 s9, s5, 18
s_lshr_b32 s6, s9, 2
s_min_u32 s6, s6, 2
s_and_b32 s7, s9, 3
s_sub_u32 s10, s9, 6
s_cmp_ge_u32 s9, 12
s_cselect_b32 s7, s10, s7
s_lshl_b32 s8, s6, 3
s_add_u32 s8, s8, s7
s_lshl_b32 s8, s8, 2
s_add_u32 s8, s8, s3
s_lshl_b32 s8, s8, 8
s_add_u32 s8, s8, s13
s_add_u32 s8, s8, 40960
s_add_u32 s10, s8, 4096
s_cmp_ge_u32 s5, 28
s_cselect_b32 s10, 0x7f000000, s10
s_cmp_lt_u32 s5, 18
s_cselect_b32 s10, 0x7f000000, s10
s_cselect_b32 s8, 0x7f000000, s8
s_mov_b64 exec, 0xffff
buffer_store_dwordx4 v[76:79], v69, s[44:47], s8 offen sc1
buffer_store_dwordx4 v[76:79], v69, s[44:47], s10 offen sc1
s_mov_b64 exec, -1
s_mov_b32 s101, s10
s_add_u32 s98, s35, 4096
s_mov_b32 m0, s98
s_add_u32 s98, s100, 4096
s_and_b32 s98, s98, 0xffff
buffer_load_dwordx4 v80, s[36:39], s98 offen offset:0 nt lds
buffer_load_dwordx4 v81, s[36:39], s98 offen offset:1024 nt lds
buffer_load_dwordx4 v82, s[36:39], s98 offen offset:2048 nt lds
buffer_load_dwordx4 v83, s[36:39], s98 offen offset:3072 nt lds
s_add_u32 s98, s35, 8192
s_mov_b32 m0, s98
s_add_u32 s98, s100, 8192
s_and_b32 s98, s98, 0xffff
buffer_load_dwordx4 v80, s[36:39], s98 offen offset:0 nt lds
buffer_load_dwordx4 v81, s[36:39], s98 offen offset:1024 nt lds
buffer_load_dwordx4 v82, s[36:39], s98 offen offset:2048 nt lds
buffer_load_dwordx4 v83, s[36:39], s98 offen offset:3072 nt lds
s_add_u32 s98, s35, 12288
s_mov_b32 m0, s98
s_add_u32 s98, s100, 12288
s_and_b32 s98, s98, 0xffff
buffer_load_dwordx4 v80, s[36:39], s98 offen offset:0 nt lds
buffer_load_dwordx4 v81, s[36:39], s98 offen offset:1024 nt lds
buffer_load_dwordx4 v82, s[36:39], s98 offen offset:2048 nt lds
buffer_load_dwordx4 v83, s[36:39], s98 offen offset:3072 nt lds
s_add_u32 s40, s84, s11
s_addc_u32 s41, s85, 0
s_and_b32 s41, s41, 0xffff
s_mov_b32 s42, 65536
s_mov_b32 s43, 0x20000
s_mov_b32 s68, s80
s_and_b32 s69, s81, 0xffff
s_mov_b32 s70, 4608
s_mov_b32 s71, 0x20000
s_mov_b32 s48, s86
s_and_b32 s49, s87, 0xffff
s_mov_b32 s50, 4718592
s_mov_b32 s51, 0x20000
s_mov_b32 s52, s88
s_and_b32 s53, s89, 0xffff
s_mov_b32 s54, 4718592
s_mov_b32 s55, 0x20000
s_mov_b32 s56, s92
s_and_b32 s57, s93, 0xffff
s_mov_b32 s58, 5308416
s_mov_b32 s59, 0x20000
s_mov_b32 s60, s94
s_and_b32 s61, s95, 0xffff
s_mov_b32 s62, 5308416
s_mov_b32 s63, 0x20000
s_mov_b32 s64, s20
s_and_b32 s65, s21, 0xffff
s_mov_b32 s66, 5308416
s_mov_b32 s67, 0x20000
s_mov_b32 s72, s22
s_and_b32 s73, s23, 0xffff
s_mov_b32 s74, 4608
s_mov_b32 s75, 0x20000
s_mov_b32 s76, s24
s_and_b32 s77, s25, 0xffff
s_mov_b32 s78, 256
s_mov_b32 s79, 0x20000
s_lshr_b32 s80, s5, 4
s_bfe_u32 s81, s5, 0x20002
s_and_b32 s82, s5, 3
s_mul_i32 s84, s5, 29
s_lshr_b32 s84, s84, 8
s_mul_i32 s83, s84, 9
s_sub_u32 s83, s5, s83
s_mov_b32 s30, 0x000f000f
s_mov_b32 s31, 0x000f000f
s_mov_b32 s32, 0xffff
s_mov_b32 s33, 0
v_lshrrev_b32 v66, 2, v65
v_and_b32 v67, 3, v65
s_mov_b32 s87, s8
s_mov_b32 s88, s101
s_cmp_lt_u32 s5, 18
s_cbranch_scc1 L1
s_mul_i32 s85, s6, 1572864
s_lshl_b32 s9, s4, 10
s_add_u32 s85, s85, s9
s_lshl_b32 s9, s7, 7
s_add_u32 s85, s85, s9
v_lshrrev_b32 v5, 3, v0
v_and_b32 v6, 2, v5
v_xor_b32 v6, v6, v0
v_and_b32 v6, 7, v6
v_mul_u32_u24 v124, 8192, v5
v_lshl_add_u32 v124, v6, 4, v124
v_xor_b32 v125, 64, v124
s_mul_i32 s9, s3, 393216
s_add_u32 s9, s9, s85
s_mul_i32 s10, s3, 6144
s_add_u32 s10, s10, 131072
s_mov_b32 m0, s10
s_nop 0
buffer_load_dwordx4 v124, s[48:51], s9 offen  lds
s_add_u32 s9, s9, 65536
s_add_u32 s10, s10, 1024
s_mov_b32 m0, s10
s_nop 0
buffer_load_dwordx4 v125, s[48:51], s9 offen  lds
s_add_u32 s9, s9, 65536
s_add_u32 s10, s10, 1024
s_mov_b32 m0, s10
s_nop 0
buffer_load_dwordx4 v124, s[48:51], s9 offen  lds
s_add_u32 s9, s9, 65536
s_add_u32 s10, s10, 1024
s_mov_b32 m0, s10
s_nop 0
buffer_load_dwordx4 v125, s[48:51], s9 offen  lds
s_add_u32 s9, s9, 65536
s_add_u32 s10, s10, 1024
s_mov_b32 m0, s10
s_nop 0
buffer_load_dwordx4 v124, s[48:51], s9 offen  lds
s_add_u32 s9, s9, 65536
s_add_u32 s10, s10, 1024
s_mov_b32 m0, s10
s_nop 0
buffer_load_dwordx4 v125, s[48:51], s9 offen  lds
s_add_u32 s85, s85, 512
v_mul_u32_u24 v5, 1152, v67
v_lshl_add_u32 v5, v66, 3, v5
v_lshl_add_u32 v5, v64, 1, v5
s_sub_u32 s9, s5, 23
s_lshl_b32 s9, s9, 2
s_add_u32 s9, s9, s3
s_lshl_b32 s9, s9, 5
s_max_i32 s9, s9, 0
buffer_load_ushort v8, v5, s[68:71], s9 offen
v_and_b32 v4, 15, v0
v_cmp_eq_u32 vcc, 4, v4
v_mov_b32 v4, 0x3f803f80
s_nop 0
v_cndmask_b32 v88, 0, v4, vcc
v_mov_b32 v89, v88
v_mov_b32 v90, v88
v_mov_b32 v91, v88
v_mov_b32 v92, v88
v_mov_b32 v93, v88
v_mov_b32 v94, v88
v_mov_b32 v95, v88
v_mov_b32 v96, v88
v_mov_b32 v97, v88
v_mov_b32 v98, v88
v_mov_b32 v99, v88
v_mov_b32 v100, v88
v_mov_b32 v101, v88
v_mov_b32 v102, v88
v_mov_b32 v103, v88
v_mov_b32 v104, v88
v_mov_b32 v105, v88
v_mov_b32 v106, v88
v_mov_b32 v107, v88
v_mov_b32 v108, v88
v_mov_b32 v109, v88
v_mov_b32 v110, v88
v_mov_b32 v111, v88
v_and_b32 v5, 3, v0
v_mul_u32_u24 v5, 1152, v5
v_lshrrev_b32 v4, 4, v0
v_lshl_add_u32 v5, v4, 4, v5
s_mul_i32 s9, s6, 384
s_mov_b64 exec, s[30:31]
buffer_load_dwordx4 v[88:91], v5, s[68:71], s9 offen offset:0
buffer_load_dwordx4 v[92:95], v5, s[68:71], s9 offen offset:64
buffer_load_dwordx4 v[96:99], v5, s[68:71], s9 offen offset:128
buffer_load_dwordx4 v[100:103], v5, s[68:71], s9 offen offset:192
buffer_load_dwordx4 v[104:107], v5, s[68:71], s9 offen offset:256
buffer_load_dwordx4 v[108:111], v5, s[68:71], s9 offen offset:320
s_mov_b64 exec, -1
v_mul_u32_u24 v5, 1152, v67
v_lshrrev_b32 v4, 2, v0
v_lshl_add_u32 v5, v4, 4, v5
v_mov_b32 v144, 0
v_mov_b32 v145, 0
v_mov_b32 v146, 0
v_mov_b32 v147, 0
buffer_load_dwordx4 v[128:131], v5, s[68:71], 0 offen offset:0
buffer_load_dwordx4 v[132:135], v5, s[68:71], 0 offen offset:256
buffer_load_dwordx4 v[136:139], v5, s[68:71], 0 offen offset:512
buffer_load_dwordx4 v[140:143], v5, s[68:71], 0 offen offset:768
s_mov_b32 exec_hi, 0
buffer_load_dwordx4 v[144:147], v5, s[68:71], 0 offen offset:1024
s_mov_b32 exec_hi, -1
s_branch L2
L1:
v_lshrrev_b32 v5, 3, v0
v_and_b32 v6, 2, v5
v_xor_b32 v6, v6, v0
v_and_b32 v6, 7, v6
v_mul_u32_u24 v124, 1152, v5
v_lshl_add_u32 v124, v6, 4, v124
v_xor_b32 v125, 64, v124
s_lshl_b32 s9, s4, 1
s_add_u32 s9, s9, s84
s_lshl_b32 s9, s9, 2
s_add_u32 s9, s9, s3
s_mul_i32 s9, s9, 73728
s_lshl_b32 s10, s83, 7
s_add_u32 s9, s9, s10
s_lshl_b32 s10, s3, 13
s_add_u32 s10, s10, 131072
s_mov_b32 m0, s10
s_nop 0
buffer_load_dwordx4 v124, s[52:55], s9 offen  lds
s_add_u32 s9, s9, 9216
s_add_u32 s10, s10, 1024
s_mov_b32 m0, s10
s_nop 0
buffer_load_dwordx4 v125, s[52:55], s9 offen  lds
s_add_u32 s9, s9, 9216
s_add_u32 s10, s10, 1024
s_mov_b32 m0, s10
s_nop 0
buffer_load_dwordx4 v124, s[52:55], s9 offen  lds
s_add_u32 s9, s9, 9216
s_add_u32 s10, s10, 1024
s_mov_b32 m0, s10
s_nop 0
buffer_load_dwordx4 v125, s[52:55], s9 offen  lds
s_add_u32 s9, s9, 9216
s_add_u32 s10, s10, 1024
s_mov_b32 m0, s10
s_nop 0
buffer_load_dwordx4 v124, s[52:55], s9 offen  lds
s_add_u32 s9, s9, 9216
s_add_u32 s10, s10, 1024
s_mov_b32 m0, s10
s_nop 0
buffer_load_dwordx4 v125, s[52:55], s9 offen  lds
s_add_u32 s9, s9, 9216
s_add_u32 s10, s10, 1024
s_mov_b32 m0, s10
s_nop 0
buffer_load_dwordx4 v124, s[52:55], s9 offen  lds
s_add_u32 s9, s9, 9216
s_add_u32 s10, s10, 1024
s_mov_b32 m0, s10
s_nop 0
buffer_load_dwordx4 v125, s[52:55], s9 offen  lds
L2:
s_add_u32 s98, s35, 16384
s_mov_b32 m0, s98
s_add_u32 s98, s100, 16384
s_and_b32 s98, s98, 0xffff
buffer_load_dwordx4 v80, s[36:39], s98 offen offset:0 nt lds
buffer_load_dwordx4 v81, s[36:39], s98 offen offset:1024 nt lds
buffer_load_dwordx4 v82, s[36:39], s98 offen offset:2048 nt lds
buffer_load_dwordx4 v83, s[36:39], s98 offen offset:3072 nt lds
s_add_u32 s98, s35, 20480
s_mov_b32 m0, s98
s_add_u32 s98, s100, 20480
s_and_b32 s98, s98, 0xffff
buffer_load_dwordx4 v80, s[36:39], s98 offen offset:0 nt lds
buffer_load_dwordx4 v81, s[36:39], s98 offen offset:1024 nt lds
buffer_load_dwordx4 v82, s[36:39], s98 offen offset:2048 nt lds
buffer_load_dwordx4 v83, s[36:39], s98 offen offset:3072 nt lds
s_add_u32 s98, s35, 24576
s_mov_b32 m0, s98
s_add_u32 s98, s100, 24576
s_and_b32 s98, s98, 0xffff
buffer_load_dwordx4 v80, s[36:39], s98 offen offset:0 nt lds
buffer_load_dwordx4 v81, s[36:39], s98 offen offset:1024 nt lds
buffer_load_dwordx4 v82, s[36:39], s98 offen offset:2048 nt lds
buffer_load_dwordx4 v83, s[36:39], s98 offen offset:3072 nt lds
s_add_u32 s98, s35, 28672
s_mov_b32 m0, s98
s_add_u32 s98, s100, 28672
s_and_b32 s98, s98, 0xffff
buffer_load_dwordx4 v80, s[36:39], s98 offen offset:0 nt lds
buffer_load_dwordx4 v81, s[36:39], s98 offen offset:1024 nt lds
buffer_load_dwordx4 v82, s[36:39], s98 offen offset:2048 nt lds
buffer_load_dwordx4 v83, s[36:39], s98 offen offset:3072 nt lds
v_and_b32 v5, 1, v64
v_lshlrev_b32 v5, 1, v5
v_xor_b32 v5, v5, v65
v_lshlrev_b32 v5, 4, v5
v_lshl_add_u32 v70, v64, 8, v5
v_xor_b32 v71, 64, v70
v_xor_b32 v72, 128, v70
v_xor_b32 v73, 192, v70
s_mov_b32 s6, 0
s_mov_b32 s8, 0
s_mov_b32 s34, 0x3e0293ee
s_mov_b32 s14, 0x00030003
s_mov_b32 s15, 0x00030003
s_lshl_b64 s[16:17], s[14:15], 2
s_lshl_b64 s[18:19], s[14:15], 4
s_lshl_b64 s[20:21], s[14:15], 6
s_lshl_b64 s[22:23], s[14:15], 8
s_lshl_b64 s[24:25], s[14:15], 10
s_lshl_b64 s[26:27], s[14:15], 12
s_lshl_b64 s[28:29], s[14:15], 14
s_getreg_b32 s9, hwreg(HW_REG_XCC_ID, 0, 4)
s_mul_i32 s10, s9, s9
s_lshl_b32 s10, s10, 18
s_lshl_b32 s9, s9, 8
s_add_u32 s9, s9, s10
s_add_u32 s7, s9, 1
v_lshl_add_u32 v1, v64, 3, v66
v_lshlrev_b32 v1, 7, v1
v_lshrrev_b32 v5, 1, v66
v_and_b32 v6, 1, v64
v_lshl_add_u32 v5, v6, 1, v5
v_lshl_add_u32 v1, v5, 5, v1
v_lshl_add_u32 v1, v67, 3, v1
v_lshrrev_b32 v5, 1, v66
v_lshl_add_u32 v5, v5, 1, v6
v_and_b32 v6, 1, v66
v_lshl_add_u32 v2, v5, 4, v6
v_lshrrev_b32 v4, 1, v64
v_lshl_add_u32 v2, v4, 2, v2
v_lshlrev_b32 v2, 8, v2
v_lshl_add_u32 v5, v5, 1, v6
v_lshl_add_u32 v2, v5, 5, v2
v_lshl_add_u32 v2, v67, 3, v2
v_add_u32 v2, s35, v2
v_and_b32 v5, 2, v0
v_cmp_eq_u32 vcc, 0, v5
v_mov_b32 v5, 0xeeee
v_mov_b32 v6, 0x4444
v_cndmask_b32 v3, v5, v6, vcc
v_lshlrev_b32 v77, 2, v0
s_waitcnt vmcnt(36)
s_barrier
s_cmp_lg_u32 s3, 0
s_cbranch_scc1 L3
v_mov_b32 v5, s7
v_mov_b32 v6, 0
s_lshl_b32 s9, s4, 2
s_mov_b64 exec, 1
buffer_atomic_add v5, v6, s[76:79], s9 offen sc1
s_mov_b64 exec, -1
L3:
s_waitcnt vmcnt(40)
ds_read_b128 a[0:3], v84 offset:0
ds_read_b128 a[4:7], v85 offset:0
ds_read_b128 a[8:11], v86 offset:0
ds_read_b128 a[12:15], v87 offset:0
s_waitcnt vmcnt(32)
ds_read_b128 a[16:19], v84 offset:4096
ds_read_b128 a[20:23], v85 offset:4096
ds_read_b128 a[24:27], v86 offset:4096
ds_read_b128 a[28:31], v87 offset:4096
s_waitcnt lgkmcnt(4)
s_add_u32 s98, s35, 0
s_mov_b32 m0, s98
s_add_u32 s98, s100, 32768
s_and_b32 s98, s98, 0xffff
buffer_load_dwordx4 v80, s[36:39], s98 offen offset:0 nt lds
buffer_load_dwordx4 v81, s[36:39], s98 offen offset:1024 nt lds
buffer_load_dwordx4 v82, s[36:39], s98 offen offset:2048 nt lds
buffer_load_dwordx4 v83, s[36:39], s98 offen offset:3072 nt lds
s_waitcnt vmcnt(32)
ds_read_b128 a[32:35], v84 offset:8192
ds_read_b128 a[36:39], v85 offset:8192
ds_read_b128 a[40:43], v86 offset:8192
ds_read_b128 a[44:47], v87 offset:8192
s_waitcnt lgkmcnt(4)
s_add_u32 s98, s35, 4096
s_mov_b32 m0, s98
s_add_u32 s98, s100, 36864
s_and_b32 s98, s98, 0xffff
buffer_load_dwordx4 v80, s[36:39], s98 offen offset:0 nt lds
buffer_load_dwordx4 v81, s[36:39], s98 offen offset:1024 nt lds
buffer_load_dwordx4 v82, s[36:39], s98 offen offset:2048 nt lds
buffer_load_dwordx4 v83, s[36:39], s98 offen offset:3072 nt lds
s_waitcnt vmcnt(32)
ds_read_b128 a[48:51], v84 offset:12288
ds_read_b128 a[52:55], v85 offset:12288
ds_read_b128 a[56:59], v86 offset:12288
ds_read_b128 a[60:63], v87 offset:12288
s_waitcnt lgkmcnt(4)
s_add_u32 s98, s35, 8192
s_mov_b32 m0, s98
s_add_u32 s98, s100, 40960
s_and_b32 s98, s98, 0xffff
buffer_load_dwordx4 v80, s[36:39], s98 offen offset:0 nt lds
buffer_load_dwordx4 v81, s[36:39], s98 offen offset:1024 nt lds
buffer_load_dwordx4 v82, s[36:39], s98 offen offset:2048 nt lds
buffer_load_dwordx4 v83, s[36:39], s98 offen offset:3072 nt lds
s_waitcnt vmcnt(24)
ds_read_b128 a[64:67], v84 offset:16384
ds_read_b128 a[68:71], v85 offset:16384
ds_read_b128 a[72:75], v86 offset:16384
ds_read_b128 a[76:79], v87 offset:16384
s_waitcnt lgkmcnt(4)
s_add_u32 s98, s35, 12288
s_mov_b32 m0, s98
s_add_u32 s98, s100, 45056
s_and_b32 s98, s98, 0xffff
buffer_load_dwordx4 v80, s[36:39], s98 offen offset:0 nt lds
buffer_load_dwordx4 v81, s[36:39], s98 offen offset:1024 nt lds
buffer_load_dwordx4 v82, s[36:39], s98 offen offset:2048 nt lds
buffer_load_dwordx4 v83, s[36:39], s98 offen offset:3072 nt lds
s_barrier
s_cmp_ge_u32 s5, 18
s_cbranch_scc1 L4
s_lshl_b32 s9, s3, 5
v_xor_b32 v5, s9, v1
v_add_u32 v5, 131072, v5
ds_read_b64_tr_b16 v[8:9], v5 offset:0
ds_read_b64_tr_b16 v[10:11], v5 offset:512
ds_read_b64_tr_b16 v[12:13], v5 offset:4096
ds_read_b64_tr_b16 v[14:15], v5 offset:4608
ds_read_b64_tr_b16 v[16:17], v5 offset:8192
ds_read_b64_tr_b16 v[18:19], v5 offset:8704
ds_read_b64_tr_b16 v[20:21], v5 offset:12288
ds_read_b64_tr_b16 v[22:23], v5 offset:12800
ds_read_b64_tr_b16 v[24:25], v5 offset:16384
ds_read_b64_tr_b16 v[26:27], v5 offset:16896
ds_read_b64_tr_b16 v[28:29], v5 offset:20480
ds_read_b64_tr_b16 v[30:31], v5 offset:20992
ds_read_b64_tr_b16 v[32:33], v5 offset:24576
ds_read_b64_tr_b16 v[34:35], v5 offset:25088
ds_read_b64_tr_b16 v[36:37], v5 offset:28672
ds_read_b64_tr_b16 v[38:39], v5 offset:29184
s_waitcnt lgkmcnt(0)
s_barrier
s_branch L5
L4:
s_lshl_b32 s9, s3, 5
v_xor_b32 v5, s9, v1
v_add_u32 v5, 131072, v5
ds_read_b64_tr_b16 v[40:41], v5 offset:0
ds_read_b64_tr_b16 v[42:43], v5 offset:512
ds_read_b64_tr_b16 v[44:45], v5 offset:4096
ds_read_b64_tr_b16 v[46:47], v5 offset:4608
ds_read_b64_tr_b16 v[48:49], v5 offset:8192
ds_read_b64_tr_b16 v[50:51], v5 offset:8704
ds_read_b64_tr_b16 v[52:53], v5 offset:12288
ds_read_b64_tr_b16 v[54:55], v5 offset:12800
ds_read_b64_tr_b16 v[56:57], v5 offset:16384
ds_read_b64_tr_b16 v[58:59], v5 offset:16896
ds_read_b64_tr_b16 v[60:61], v5 offset:20480
ds_read_b64_tr_b16 v[62:63], v5 offset:20992
v_lshlrev_b32 v8, 16, v8
v_mov_b32 v112, 0
v_mov_b32 v113, 0
v_mov_b32 v6, 0x3f803f80
v_dot2c_f32_bf16 v112, v6, v128
v_dot2c_f32_bf16 v113, v128, v128
v_dot2c_f32_bf16 v112, v6, v129
v_dot2c_f32_bf16 v113, v129, v129
v_dot2c_f32_bf16 v112, v6, v130
v_dot2c_f32_bf16 v113, v130, v130
v_dot2c_f32_bf16 v112, v6, v131
v_dot2c_f32_bf16 v113, v131, v131
v_dot2c_f32_bf16 v112, v6, v132
v_dot2c_f32_bf16 v113, v132, v132
v_dot2c_f32_bf16 v112, v6, v133
v_dot2c_f32_bf16 v113, v133, v133
v_dot2c_f32_bf16 v112, v6, v134
v_dot2c_f32_bf16 v113, v134, v134
v_dot2c_f32_bf16 v112, v6, v135
v_dot2c_f32_bf16 v113, v135, v135
v_dot2c_f32_bf16 v112, v6, v136
v_dot2c_f32_bf16 v113, v136, v136
v_dot2c_f32_bf16 v112, v6, v137
v_dot2c_f32_bf16 v113, v137, v137
v_dot2c_f32_bf16 v112, v6, v138
v_dot2c_f32_bf16 v113, v138, v138
v_dot2c_f32_bf16 v112, v6, v139
v_dot2c_f32_bf16 v113, v139, v139
v_dot2c_f32_bf16 v112, v6, v140
v_dot2c_f32_bf16 v113, v140, v140
v_dot2c_f32_bf16 v112, v6, v141
v_dot2c_f32_bf16 v113, v141, v141
v_dot2c_f32_bf16 v112, v6, v142
v_dot2c_f32_bf16 v113, v142, v142
v_dot2c_f32_bf16 v112, v6, v143
v_dot2c_f32_bf16 v113, v143, v143
v_dot2c_f32_bf16 v112, v6, v144
v_dot2c_f32_bf16 v113, v144, v144
v_dot2c_f32_bf16 v112, v6, v145
v_dot2c_f32_bf16 v113, v145, v145
v_dot2c_f32_bf16 v112, v6, v146
v_dot2c_f32_bf16 v113, v146, v146
v_dot2c_f32_bf16 v112, v6, v147
v_dot2c_f32_bf16 v113, v147, v147
s_waitcnt lgkmcnt(0)
s_barrier
s_cmp_ge_u32 s5, 28
s_cbranch_scc1 L5
v_lshrrev_b32 v5, 3, v0
v_and_b32 v6, 2, v5
v_xor_b32 v6, v6, v0
v_and_b32 v6, 7, v6
v_mul_u32_u24 v124, 8192, v5
v_lshl_add_u32 v124, v6, 4, v124
v_xor_b32 v125, 64, v124
s_mul_i32 s9, s3, 393216
s_add_u32 s9, s9, s85
s_mul_i32 s10, s3, 6144
s_add_u32 s10, s10, 131072
s_mov_b32 m0, s10
s_nop 0
buffer_load_dwordx4 v124, s[48:51], s9 offen  lds
s_add_u32 s9, s9, 65536
s_add_u32 s10, s10, 1024
s_mov_b32 m0, s10
s_nop 0
buffer_load_dwordx4 v125, s[48:51], s9 offen  lds
s_add_u32 s9, s9, 65536
s_add_u32 s10, s10, 1024
s_mov_b32 m0, s10
s_nop 0
buffer_load_dwordx4 v124, s[48:51], s9 offen  lds
s_add_u32 s9, s9, 65536
s_add_u32 s10, s10, 1024
s_mov_b32 m0, s10
s_nop 0
buffer_load_dwordx4 v125, s[48:51], s9 offen  lds
s_add_u32 s9, s9, 65536
s_add_u32 s10, s10, 1024
s_mov_b32 m0, s10
s_nop 0
buffer_load_dwordx4 v124, s[48:51], s9 offen  lds
s_add_u32 s9, s9, 65536
s_add_u32 s10, s10, 1024
s_mov_b32 m0, s10
s_nop 0
buffer_load_dwordx4 v125, s[48:51], s9 offen  lds
L5:
s_waitcnt vmcnt(24)
ds_read_b128 a[80:83], v84 offset:20480
ds_read_b128 a[84:87], v85 offset:20480
ds_read_b128 a[88:91], v86 offset:20480
ds_read_b128 a[92:95], v87 offset:20480
s_waitcnt lgkmcnt(4)
s_add_u32 s98, s35, 16384
s_mov_b32 m0, s98
s_add_u32 s98, s100, 49152
s_and_b32 s98, s98, 0xffff
buffer_load_dwordx4 v80, s[36:39], s98 offen offset:0 nt lds
buffer_load_dwordx4 v81, s[36:39], s98 offen offset:1024 nt lds
buffer_load_dwordx4 v82, s[36:39], s98 offen offset:2048 nt lds
buffer_load_dwordx4 v83, s[36:39], s98 offen offset:3072 nt lds
s_waitcnt vmcnt(24)
ds_read_b128 a[96:99], v84 offset:24576
ds_read_b128 a[100:103], v85 offset:24576
ds_read_b128 a[104:107], v86 offset:24576
ds_read_b128 a[108:111], v87 offset:24576
s_waitcnt lgkmcnt(4)
s_add_u32 s98, s35, 20480
s_mov_b32 m0, s98
s_add_u32 s98, s100, 53248
s_and_b32 s98, s98, 0xffff
buffer_load_dwordx4 v80, s[36:39], s98 offen offset:0 nt lds
buffer_load_dwordx4 v81, s[36:39], s98 offen offset:1024 nt lds
buffer_load_dwordx4 v82, s[36:39], s98 offen offset:2048 nt lds
buffer_load_dwordx4 v83, s[36:39], s98 offen offset:3072 nt lds
s_waitcnt vmcnt(24)
ds_read_b128 a[112:115], v84 offset:28672
ds_read_b128 a[116:119], v85 offset:28672
ds_read_b128 a[120:123], v86 offset:28672
ds_read_b128 a[124:127], v87 offset:28672
s_waitcnt lgkmcnt(4)
s_add_u32 s98, s35, 24576
s_mov_b32 m0, s98
s_add_u32 s98, s100, 57344
s_and_b32 s98, s98, 0xffff
buffer_load_dwordx4 v80, s[36:39], s98 offen offset:0 nt lds
buffer_load_dwordx4 v81, s[36:39], s98 offen offset:1024 nt lds
buffer_load_dwordx4 v82, s[36:39], s98 offen offset:2048 nt lds
buffer_load_dwordx4 v83, s[36:39], s98 offen offset:3072 nt lds
s_cmp_lt_u32 s5, 18
s_cbranch_scc1 L6
s_waitcnt vmcnt(12)
s_barrier
s_lshl_b32 s9, s3, 5
v_xor_b32 v5, s9, v1
v_add_u32 v5, 131072, v5
ds_read_b64_tr_b16 v[12:13], v5 offset:0
ds_read_b64_tr_b16 v[14:15], v5 offset:512
ds_read_b64_tr_b16 v[16:17], v5 offset:4096
ds_read_b64_tr_b16 v[18:19], v5 offset:4608
ds_read_b64_tr_b16 v[20:21], v5 offset:8192
ds_read_b64_tr_b16 v[22:23], v5 offset:8704
ds_read_b64_tr_b16 v[24:25], v5 offset:12288
ds_read_b64_tr_b16 v[26:27], v5 offset:12800
ds_read_b64_tr_b16 v[28:29], v5 offset:16384
ds_read_b64_tr_b16 v[30:31], v5 offset:16896
ds_read_b64_tr_b16 v[32:33], v5 offset:20480
ds_read_b64_tr_b16 v[34:35], v5 offset:20992
v_mov_b32 v4, v112
s_waitcnt lgkmcnt(0)
v_mov_b32 v5, v113
v_mfma_f32_16x16x32_bf16 v[120:123], v[40:43], v[88:91], 0
v_mfma_f32_16x16x32_bf16 v[124:127], v[12:15], v[88:91], 0
v_permlane32_swap_b32 v4, v5
v_add_f32 v4, v4, v5
v_mfma_f32_16x16x32_bf16 v[120:123], v[44:47], v[92:95], v[120:123]
s_nop 0
v_add_f32_dpp v4, v4, v4 row_ror:4 row_mask:0xf bank_mask:0xf
v_mfma_f32_16x16x32_bf16 v[124:127], v[16:19], v[92:95], v[124:127]
s_nop 0
v_add_f32_dpp v4, v4, v4 row_ror:8 row_mask:0xf bank_mask:0xf
v_mov_b32 v5, v4
v_mfma_f32_16x16x32_bf16 v[120:123], v[48:51], v[96:99], v[120:123]
s_nop 0
v_permlane16_swap_b32 v4, v5
v_add_f32 v4, v4, v5
v_mfma_f32_16x16x32_bf16 v[124:127], v[20:23], v[96:99], v[124:127]
v_mov_b32 v5, v4
v_mfma_f32_16x16x32_bf16 v[120:123], v[52:55], v[100:103], v[120:123]
s_nop 0
v_permlane32_swap_b32 v4, v5
v_mul_f32 v4, 0xbae38e39, v4
v_mfma_f32_16x16x32_bf16 v[124:127], v[24:27], v[100:103], v[124:127]
v_mul_f32 v5, 0x3ae38e39, v5
v_fma_f32 v5, -v4, v4, v5
v_mfma_f32_16x16x32_bf16 v[120:123], v[56:59], v[104:107], v[120:123]
v_max_f32 v5, 0, v5
v_add_f32 v5, 0x3727c5ac, v5
v_mfma_f32_16x16x32_bf16 v[124:127], v[28:31], v[104:107], v[124:127]
v_rsq_f32 v5, v5
v_mfma_f32_16x16x32_bf16 v[120:123], v[60:63], v[108:111], v[120:123]
v_mfma_f32_16x16x32_bf16 v[124:127], v[32:35], v[108:111], v[124:127]
s_nop 6
v_fmac_f32_dpp v120, v120, v4 row_newbcast:4 row_mask:0xf bank_mask:0xf
v_fmac_f32_dpp v121, v121, v4 row_newbcast:4 row_mask:0xf bank_mask:0xf
v_fmac_f32_dpp v122, v122, v4 row_newbcast:4 row_mask:0xf bank_mask:0xf
v_fmac_f32_dpp v123, v123, v4 row_newbcast:4 row_mask:0xf bank_mask:0xf
v_fmac_f32_dpp v124, v124, v4 row_newbcast:4 row_mask:0xf bank_mask:0xf
v_fmac_f32_dpp v125, v125, v4 row_newbcast:4 row_mask:0xf bank_mask:0xf
v_fmac_f32_dpp v126, v126, v4 row_newbcast:4 row_mask:0xf bank_mask:0xf
v_fmac_f32_dpp v127, v127, v4 row_newbcast:4 row_mask:0xf bank_mask:0xf
v_pk_mul_f32 v[120:121], v[120:121], v[4:5] op_sel:[0,1] op_sel_hi:[1,1]
v_pk_mul_f32 v[122:123], v[122:123], v[4:5] op_sel:[0,1] op_sel_hi:[1,1]
v_pk_mul_f32 v[124:125], v[124:125], v[4:5] op_sel:[0,1] op_sel_hi:[1,1]
v_pk_mul_f32 v[126:127], v[126:127], v[4:5] op_sel:[0,1] op_sel_hi:[1,1]
v_and_b32 v76, 15, v0
v_lshlrev_b32 v76, 6, v76
v_lshrrev_b32 v4, 4, v0
v_lshl_add_u32 v76, v4, 4, v76
s_mov_b64 exec, s[30:31]
buffer_store_dwordx4 v[120:123], v76, s[44:47], s87 offen sc1
buffer_store_dwordx4 v[124:127], v76, s[44:47], s88 offen sc1
s_mov_b64 exec, -1
s_nop 0
L6:
buffer_load_dword v74, v77, s[76:79], 0 offen sc1
s_waitcnt vmcnt(25)
ds_read_b128 a[128:131], v84 offset:0
ds_read_b128 a[132:135], v85 offset:0
ds_read_b128 a[136:139], v86 offset:0
ds_read_b128 a[140:143], v87 offset:0
s_waitcnt lgkmcnt(4)
s_add_u32 s98, s35, 28672
s_mov_b32 m0, s98
s_add_u32 s98, s100, 61440
s_and_b32 s98, s98, 0xffff
buffer_load_dwordx4 v80, s[36:39], s98 offen offset:0 nt lds
buffer_load_dwordx4 v81, s[36:39], s98 offen offset:1024 nt lds
buffer_load_dwordx4 v82, s[36:39], s98 offen offset:2048 nt lds
buffer_load_dwordx4 v83, s[36:39], s98 offen offset:3072 nt lds
s_waitcnt vmcnt(25)
ds_read_b128 a[144:147], v84 offset:4096
ds_read_b128 a[148:151], v85 offset:4096
ds_read_b128 a[152:155], v86 offset:4096
ds_read_b128 a[156:159], v87 offset:4096
s_waitcnt lgkmcnt(4)
s_add_u32 s99, s35, 0
s_mov_b32 m0, s99
s_add_u32 s99, s100, 0
s_and_b32 s99, s99, 0xffff
buffer_load_dwordx4 v70, s[40:43], s99 offen offset:0 nt lds
buffer_load_dwordx4 v70, s[40:43], s99 offen offset:1024 nt lds
buffer_load_dwordx4 v70, s[40:43], s99 offen offset:2048 nt lds
buffer_load_dwordx4 v70, s[40:43], s99 offen offset:3072 nt lds
s_waitcnt vmcnt(25)
ds_read_b128 a[160:163], v84 offset:8192
ds_read_b128 a[164:167], v85 offset:8192
ds_read_b128 a[168:171], v86 offset:8192
ds_read_b128 a[172:175], v87 offset:8192
s_waitcnt lgkmcnt(4)
s_add_u32 s99, s35, 4096
s_mov_b32 m0, s99
s_add_u32 s99, s100, 4096
s_and_b32 s99, s99, 0xffff
buffer_load_dwordx4 v71, s[40:43], s99 offen offset:0 nt lds
buffer_load_dwordx4 v71, s[40:43], s99 offen offset:1024 nt lds
buffer_load_dwordx4 v71, s[40:43], s99 offen offset:2048 nt lds
buffer_load_dwordx4 v71, s[40:43], s99 offen offset:3072 nt lds
s_waitcnt vmcnt(25)
ds_read_b128 a[176:179], v84 offset:12288
ds_read_b128 a[180:183], v85 offset:12288
ds_read_b128 a[184:187], v86 offset:12288
ds_read_b128 a[188:191], v87 offset:12288
s_waitcnt lgkmcnt(4)
s_add_u32 s99, s35, 8192
s_mov_b32 m0, s99
s_add_u32 s99, s100, 8192
s_and_b32 s99, s99, 0xffff
buffer_load_dwordx4 v72, s[40:43], s99 offen offset:0 nt lds
buffer_load_dwordx4 v72, s[40:43], s99 offen offset:1024 nt lds
buffer_load_dwordx4 v72, s[40:43], s99 offen offset:2048 nt lds
buffer_load_dwordx4 v72, s[40:43], s99 offen offset:3072 nt lds
s_waitcnt vmcnt(25)
ds_read_b128 a[192:195], v84 offset:16384
ds_read_b128 a[196:199], v85 offset:16384
ds_read_b128 a[200:203], v86 offset:16384
ds_read_b128 a[204:207], v87 offset:16384
s_waitcnt lgkmcnt(4)
s_add_u32 s99, s35, 12288
s_mov_b32 m0, s99
s_add_u32 s99, s100, 12288
s_and_b32 s99, s99, 0xffff
buffer_load_dwordx4 v73, s[40:43], s99 offen offset:0 nt lds
buffer_load_dwordx4 v73, s[40:43], s99 offen offset:1024 nt lds
buffer_load_dwordx4 v73, s[40:43], s99 offen offset:2048 nt lds
buffer_load_dwordx4 v73, s[40:43], s99 offen offset:3072 nt lds
s_waitcnt vmcnt(25)
ds_read_b128 a[208:211], v84 offset:20480
ds_read_b128 a[212:215], v85 offset:20480
ds_read_b128 a[216:219], v86 offset:20480
ds_read_b128 a[220:223], v87 offset:20480
s_waitcnt lgkmcnt(4)
s_add_u32 s99, s35, 16384
s_mov_b32 m0, s99
s_add_u32 s99, s100, 16384
s_and_b32 s99, s99, 0xffff
buffer_load_dwordx4 v70, s[40:43], s99 offen offset:0 nt lds
buffer_load_dwordx4 v70, s[40:43], s99 offen offset:1024 nt lds
buffer_load_dwordx4 v70, s[40:43], s99 offen offset:2048 nt lds
buffer_load_dwordx4 v70, s[40:43], s99 offen offset:3072 nt lds
s_waitcnt vmcnt(24)
Lck7:
v_readlane_b32 s11, v74, s4
v_and_b32 v74, 0xff, v74
v_cmp_le_u32 vcc, 32, v74
s_add_u32 s8, s8, 1
s_andn2_b32 s9, 0xff, vcc_lo
s_cbranch_scc0 Lok8
s_cmp_gt_u32 s8, 200000
s_cbranch_scc1 Lok8
buffer_load_dword v74, v77, s[76:79], 0 offen sc1
s_waitcnt vmcnt(0)
s_branch Lck7
Lok8:
s_lshl_b32 s7, s7, 5
s_sub_u32 s7, s7, s11
s_lshl_b32 s89, s80, 12
s_add_u32 s89, s89, s13
s_add_u32 s89, s89, 40960
s_lshl_b32 s9, s81, 6
s_add_u32 s89, s89, s9
s_add_u32 s90, s89, 8192
s_add_u32 s91, s89, 16384
v_lshrrev_b32 v78, 2, v0
v_lshlrev_b32 v78, 8, v78
v_and_b32 v4, 3, v0
v_lshl_add_u32 v78, v4, 4, v78
buffer_load_dwordx4 v[40:43], v78, s[44:47], s89 offen sc1
buffer_load_dwordx4 v[44:47], v78, s[44:47], s90 offen sc1
buffer_load_dwordx4 v[48:51], v78, s[44:47], s91 offen sc1
s_getpc_b64 s[94:95]
L_pc1:
v_lshlrev_b32 v5, 7, v0
s_lshl_b32 s9, s3, 13
v_add_u32 v5, s9, v5
v_min_u32 v5, L_end-L_pc1, v5
global_load_dword v75, v5, s[94:95]
s_waitcnt vmcnt(26)
ds_read_b128 a[224:227], v84 offset:24576
ds_read_b128 a[228:231], v85 offset:24576
ds_read_b128 a[232:235], v86 offset:24576
ds_read_b128 a[236:239], v87 offset:24576
s_waitcnt lgkmcnt(4)
s_add_u32 s99, s35, 20480
s_mov_b32 m0, s99
s_add_u32 s99, s100, 20480
s_and_b32 s99, s99, 0xffff
buffer_load_dwordx4 v71, s[40:43], s99 offen offset:0 nt lds
buffer_load_dwordx4 v71, s[40:43], s99 offen offset:1024 nt lds
buffer_load_dwordx4 v71, s[40:43], s99 offen offset:2048 nt lds
buffer_load_dwordx4 v71, s[40:43], s99 offen offset:3072 nt lds
s_waitcnt vmcnt(25)
ds_read_b128 a[240:243], v84 offset:28672
ds_read_b128 a[244:247], v85 offset:28672
ds_read_b128 a[248:251], v86 offset:28672
ds_read_b128 a[252:255], v87 offset:28672
s_waitcnt lgkmcnt(4)
s_add_u32 s99, s35, 24576
s_mov_b32 m0, s99
s_add_u32 s99, s100, 24576
s_and_b32 s99, s99, 0xffff
buffer_load_dwordx4 v72, s[40:43], s99 offen offset:0 nt lds
buffer_load_dwordx4 v72, s[40:43], s99 offen offset:1024 nt lds
buffer_load_dwordx4 v72, s[40:43], s99 offen offset:2048 nt lds
buffer_load_dwordx4 v72, s[40:43], s99 offen offset:3072 nt lds
s_waitcnt lgkmcnt(0)
s_add_u32 s99, s35, 28672
s_mov_b32 m0, s99
s_add_u32 s99, s100, 28672
s_and_b32 s99, s99, 0xffff
buffer_load_dwordx4 v73, s[40:43], s99 offen offset:0 nt lds
buffer_load_dwordx4 v73, s[40:43], s99 offen offset:1024 nt lds
buffer_load_dwordx4 v73, s[40:43], s99 offen offset:2048 nt lds
buffer_load_dwordx4 v73, s[40:43], s99 offen offset:3072 nt lds
s_waitcnt vmcnt(17)
v_xor_b32 v4, 0, v2
ds_read_b64_tr_b16 v[128:129], v4 offset:0
ds_read_b64_tr_b16 v[130:131], v4 offset:512
ds_read_b64_tr_b16 v[132:133], v4 offset:2048
ds_read_b64_tr_b16 v[134:135], v4 offset:2560
v_xor_b32 v5, 32, v2
ds_read_b64_tr_b16 v[136:137], v5 offset:0
ds_read_b64_tr_b16 v[138:139], v5 offset:512
ds_read_b64_tr_b16 v[140:141], v5 offset:2048
ds_read_b64_tr_b16 v[142:143], v5 offset:2560
v_xor_b32 v4, 64, v2
ds_read_b64_tr_b16 v[144:145], v4 offset:0
ds_read_b64_tr_b16 v[146:147], v4 offset:512
ds_read_b64_tr_b16 v[148:149], v4 offset:2048
ds_read_b64_tr_b16 v[150:151], v4 offset:2560
v_xor_b32 v5, 96, v2
ds_read_b64_tr_b16 v[152:153], v5 offset:0
ds_read_b64_tr_b16 v[154:155], v5 offset:512
ds_read_b64_tr_b16 v[156:157], v5 offset:2048
ds_read_b64_tr_b16 v[158:159], v5 offset:2560
v_xor_b32 v4, 128, v2
ds_read_b64_tr_b16 v[160:161], v4 offset:0
ds_read_b64_tr_b16 v[162:163], v4 offset:512
ds_read_b64_tr_b16 v[164:165], v4 offset:2048
ds_read_b64_tr_b16 v[166:167], v4 offset:2560
v_xor_b32 v5, 160, v2
ds_read_b64_tr_b16 v[168:169], v5 offset:0
ds_read_b64_tr_b16 v[170:171], v5 offset:512
ds_read_b64_tr_b16 v[172:173], v5 offset:2048
ds_read_b64_tr_b16 v[174:175], v5 offset:2560
v_xor_b32 v4, 192, v2
ds_read_b64_tr_b16 v[176:177], v4 offset:0
ds_read_b64_tr_b16 v[178:179], v4 offset:512
ds_read_b64_tr_b16 v[180:181], v4 offset:2048
ds_read_b64_tr_b16 v[182:183], v4 offset:2560
v_xor_b32 v5, 224, v2
ds_read_b64_tr_b16 v[184:185], v5 offset:0
ds_read_b64_tr_b16 v[186:187], v5 offset:512
ds_read_b64_tr_b16 v[188:189], v5 offset:2048
ds_read_b64_tr_b16 v[190:191], v5 offset:2560
s_waitcnt lgkmcnt(0)
s_add_u32 s99, s35, 0
s_mov_b32 m0, s99
s_add_u32 s99, s100, 32768
s_and_b32 s99, s99, 0xffff
buffer_load_dwordx4 v70, s[40:43], s99 offen offset:0 nt lds
buffer_load_dwordx4 v70, s[40:43], s99 offen offset:1024 nt lds
buffer_load_dwordx4 v70, s[40:43], s99 offen offset:2048 nt lds
buffer_load_dwordx4 v70, s[40:43], s99 offen offset:3072 nt lds
s_waitcnt vmcnt(16)
Lck9:
s_add_u32 s8, s8, 1
v_max3_u32 v4, v40, v41, v42
v_max3_u32 v4, v4, v43, v44
v_max3_u32 v4, v4, v45, v46
v_max3_u32 v4, v4, v47, v48
v_max3_u32 v4, v4, v49, v50
v_max_u32 v4, v4, v51
v_cmp_eq_u32 vcc, -1, v4
s_cbranch_vccz Lok10
s_cmp_gt_u32 s8, 200000
s_cbranch_scc1 Lok10
buffer_load_dwordx4 v[40:43], v78, s[44:47], s89 offen sc1
buffer_load_dwordx4 v[44:47], v78, s[44:47], s90 offen sc1
buffer_load_dwordx4 v[48:51], v78, s[44:47], s91 offen sc1
s_waitcnt vmcnt(0)
s_branch Lck9
Lok10:
s_mul_i32 s9, s3, 576
s_add_u32 s9, s9, 160000
v_lshrrev_b32 v85, 5, v0
v_mul_u32_u24 v85, 288, v85
v_and_b32 v5, 31, v0
v_lshl_add_u32 v85, v5, 3, v85
v_add_u32 v85, s9, v85
v_and_b32 v5, 1, v0
v_mul_u32_u24 v5, 288, v5
v_lshrrev_b32 v6, 4, v0
v_lshl_add_u32 v6, v6, 4, v5
v_add_u32 v6, s9, v6
v_pk_add_f32 v[104:105], v[40:41], v[44:45]
v_pk_add_f32 v[106:107], v[42:43], v[46:47]
v_pk_add_f32 v[104:105], v[104:105], v[48:49]
v_pk_add_f32 v[106:107], v[106:107], v[50:51]
v_cvt_pk_bf16_f32 v104, v104, v105
v_cvt_pk_bf16_f32 v105, v106, v107
ds_write_b64 v85, v[104:105]
v_mov_b32 v5, v70
v_mov_b32 v40, 0
v_mov_b32 v41, 0
v_mov_b32 v42, 0
v_mov_b32 v43, 0
v_mov_b32 v44, 0
v_mov_b32 v45, 0
v_mov_b32 v46, 0
v_mov_b32 v47, 0
v_mov_b32 v48, 0
v_mov_b32 v49, 0
v_mov_b32 v50, 0
v_mov_b32 v51, 0
v_mov_b32 v52, 0
v_mov_b32 v53, 0
v_mov_b32 v54, 0
v_mov_b32 v55, 0
v_mov_b32 v56, 0
v_mov_b32 v57, 0
v_mov_b32 v58, 0
v_mov_b32 v59, 0
v_mov_b32 v60, 0
v_mov_b32 v61, 0
v_mov_b32 v62, 0
v_mov_b32 v63, 0
v_mov_b32 v64, 0
v_mov_b32 v65, 0
v_mov_b32 v66, 0
v_mov_b32 v67, 0
v_mov_b32 v68, 0
v_mov_b32 v69, 0
v_mov_b32 v70, 0
v_mov_b32 v71, 0
s_waitcnt lgkmcnt(0)
ds_read_b128 v[72:75], v6 offset:0
ds_read_b128 v[76:79], v6 offset:64
ds_read_b128 v[80:83], v6 offset:128
ds_read_b128 v[84:87], v6 offset:192
s_waitcnt lgkmcnt(3)
v_mfma_f32_16x16x32_bf16 v[112:115], a[0:3], v[72:75], 0
s_waitcnt lgkmcnt(2)
v_mfma_f32_16x16x32_bf16 v[112:115], a[4:7], v[76:79], v[112:115]
s_waitcnt lgkmcnt(1)
v_mfma_f32_16x16x32_bf16 v[112:115], a[8:11], v[80:83], v[112:115]
s_waitcnt lgkmcnt(0)
v_mfma_f32_16x16x32_bf16 v[112:115], a[12:15], v[84:87], v[112:115]
v_mfma_f32_16x16x32_bf16 v[116:119], a[16:19], v[72:75], 0
v_mfma_f32_16x16x32_bf16 v[116:119], a[20:23], v[76:79], v[116:119]
v_mfma_f32_16x16x32_bf16 v[116:119], a[24:27], v[80:83], v[116:119]
v_mfma_f32_16x16x32_bf16 v[116:119], a[28:31], v[84:87], v[116:119]
v_mfma_f32_16x16x32_bf16 v[120:123], a[32:35], v[72:75], 0
s_nop 2
v_cndmask_b32 v104, v104, v112, s[14:15]
v_mfma_f32_16x16x32_bf16 v[120:123], a[36:39], v[76:79], v[120:123]
v_cndmask_b32 v105, v105, v113, s[14:15]
v_mfma_f32_16x16x32_bf16 v[120:123], a[40:43], v[80:83], v[120:123]
v_cndmask_b32 v106, v106, v114, s[14:15]
v_mfma_f32_16x16x32_bf16 v[120:123], a[44:47], v[84:87], v[120:123]
v_cndmask_b32 v107, v107, v115, s[14:15]
v_mfma_f32_16x16x32_bf16 v[112:115], a[48:51], v[72:75], 0
v_cndmask_b32 v108, v108, v116, s[14:15]
v_mfma_f32_16x16x32_bf16 v[112:115], a[52:55], v[76:79], v[112:115]
v_cndmask_b32 v109, v109, v117, s[14:15]
v_mfma_f32_16x16x32_bf16 v[112:115], a[56:59], v[80:83], v[112:115]
v_cndmask_b32 v110, v110, v118, s[14:15]
v_mfma_f32_16x16x32_bf16 v[112:115], a[60:63], v[84:87], v[112:115]
v_cndmask_b32 v111, v111, v119, s[14:15]
v_xor_b32 v4, 64, v5
s_add_u32 s99, s35, 4096
s_mov_b32 m0, s99
s_add_u32 s99, s100, 36864
s_and_b32 s99, s99, 0xffff
buffer_load_dwordx4 v4, s[40:43], s99 offen offset:0 nt lds
buffer_load_dwordx4 v4, s[40:43], s99 offen offset:1024 nt lds
buffer_load_dwordx4 v4, s[40:43], s99 offen offset:2048 nt lds
buffer_load_dwordx4 v4, s[40:43], s99 offen offset:3072 nt lds
v_mfma_f32_16x16x32_bf16 v[116:119], a[64:67], v[72:75], 0
v_cndmask_b32 v104, v104, v120, s[16:17]
v_mfma_f32_16x16x32_bf16 v[116:119], a[68:71], v[76:79], v[116:119]
v_cndmask_b32 v105, v105, v121, s[16:17]
v_mfma_f32_16x16x32_bf16 v[116:119], a[72:75], v[80:83], v[116:119]
v_cndmask_b32 v106, v106, v122, s[16:17]
v_mfma_f32_16x16x32_bf16 v[116:119], a[76:79], v[84:87], v[116:119]
v_cndmask_b32 v107, v107, v123, s[16:17]
v_mfma_f32_16x16x32_bf16 v[120:123], a[80:83], v[72:75], 0
v_cndmask_b32 v108, v108, v112, s[16:17]
v_mfma_f32_16x16x32_bf16 v[120:123], a[84:87], v[76:79], v[120:123]
v_cndmask_b32 v109, v109, v113, s[16:17]
v_mfma_f32_16x16x32_bf16 v[120:123], a[88:91], v[80:83], v[120:123]
v_cndmask_b32 v110, v110, v114, s[16:17]
v_mfma_f32_16x16x32_bf16 v[120:123], a[92:95], v[84:87], v[120:123]
v_cndmask_b32 v111, v111, v115, s[16:17]
v_mfma_f32_16x16x32_bf16 v[112:115], a[96:99], v[72:75], 0
v_cndmask_b32 v104, v104, v116, s[18:19]
v_mfma_f32_16x16x32_bf16 v[112:115], a[100:103], v[76:79], v[112:115]
v_cndmask_b32 v105, v105, v117, s[18:19]
v_mfma_f32_16x16x32_bf16 v[112:115], a[104:107], v[80:83], v[112:115]
v_cndmask_b32 v106, v106, v118, s[18:19]
v_mfma_f32_16x16x32_bf16 v[112:115], a[108:111], v[84:87], v[112:115]
v_cndmask_b32 v107, v107, v119, s[18:19]
v_mfma_f32_16x16x32_bf16 v[116:119], a[112:115], v[72:75], 0
v_cndmask_b32 v108, v108, v120, s[18:19]
v_mfma_f32_16x16x32_bf16 v[116:119], a[116:119], v[76:79], v[116:119]
v_cndmask_b32 v109, v109, v121, s[18:19]
v_mfma_f32_16x16x32_bf16 v[116:119], a[120:123], v[80:83], v[116:119]
v_cndmask_b32 v110, v110, v122, s[18:19]
v_mfma_f32_16x16x32_bf16 v[116:119], a[124:127], v[84:87], v[116:119]
v_cndmask_b32 v111, v111, v123, s[18:19]
v_xor_b32 v4, 128, v5
s_add_u32 s99, s35, 8192
s_mov_b32 m0, s99
s_add_u32 s99, s100, 40960
s_and_b32 s99, s99, 0xffff
buffer_load_dwordx4 v4, s[40:43], s99 offen offset:0 nt lds
buffer_load_dwordx4 v4, s[40:43], s99 offen offset:1024 nt lds
buffer_load_dwordx4 v4, s[40:43], s99 offen offset:2048 nt lds
buffer_load_dwordx4 v4, s[40:43], s99 offen offset:3072 nt lds
v_mfma_f32_16x16x32_bf16 v[120:123], a[128:131], v[72:75], 0
v_cndmask_b32 v104, v104, v112, s[20:21]
v_mfma_f32_16x16x32_bf16 v[120:123], a[132:135], v[76:79], v[120:123]
v_cndmask_b32 v105, v105, v113, s[20:21]
v_mfma_f32_16x16x32_bf16 v[120:123], a[136:139], v[80:83], v[120:123]
v_cndmask_b32 v106, v106, v114, s[20:21]
v_mfma_f32_16x16x32_bf16 v[120:123], a[140:143], v[84:87], v[120:123]
v_cndmask_b32 v107, v107, v115, s[20:21]
v_mfma_f32_16x16x32_bf16 v[112:115], a[144:147], v[72:75], 0
v_cndmask_b32 v108, v108, v116, s[20:21]
v_mfma_f32_16x16x32_bf16 v[112:115], a[148:151], v[76:79], v[112:115]
v_cndmask_b32 v109, v109, v117, s[20:21]
v_mfma_f32_16x16x32_bf16 v[112:115], a[152:155], v[80:83], v[112:115]
v_cndmask_b32 v110, v110, v118, s[20:21]
v_mfma_f32_16x16x32_bf16 v[112:115], a[156:159], v[84:87], v[112:115]
v_cndmask_b32 v111, v111, v119, s[20:21]
v_mfma_f32_16x16x32_bf16 v[116:119], a[160:163], v[72:75], 0
v_cndmask_b32 v104, v104, v120, s[22:23]
v_mfma_f32_16x16x32_bf16 v[116:119], a[164:167], v[76:79], v[116:119]
v_cndmask_b32 v105, v105, v121, s[22:23]
v_mfma_f32_16x16x32_bf16 v[116:119], a[168:171], v[80:83], v[116:119]
v_cndmask_b32 v106, v106, v122, s[22:23]
v_mfma_f32_16x16x32_bf16 v[116:119], a[172:175], v[84:87], v[116:119]
v_cndmask_b32 v107, v107, v123, s[22:23]
v_mfma_f32_16x16x32_bf16 v[120:123], a[176:179], v[72:75], 0
v_cndmask_b32 v108, v108, v112, s[22:23]
v_mfma_f32_16x16x32_bf16 v[120:123], a[180:183], v[76:79], v[120:123]
v_cndmask_b32 v109, v109, v113, s[22:23]
v_mfma_f32_16x16x32_bf16 v[120:123], a[184:187], v[80:83], v[120:123]
v_cndmask_b32 v110, v110, v114, s[22:23]
v_mfma_f32_16x16x32_bf16 v[120:123], a[188:191], v[84:87], v[120:123]
v_cndmask_b32 v111, v111, v115, s[22:23]
v_xor_b32 v4, 192, v5
s_add_u32 s99, s35, 12288
s_mov_b32 m0, s99
s_add_u32 s99, s100, 45056
s_and_b32 s99, s99, 0xffff
buffer_load_dwordx4 v4, s[40:43], s99 offen offset:0 nt lds
buffer_load_dwordx4 v4, s[40:43], s99 offen offset:1024 nt lds
buffer_load_dwordx4 v4, s[40:43], s99 offen offset:2048 nt lds
buffer_load_dwordx4 v4, s[40:43], s99 offen offset:3072 nt lds
v_mfma_f32_16x16x32_bf16 v[112:115], a[192:195], v[72:75], 0
v_cndmask_b32 v104, v104, v116, s[24:25]
v_mfma_f32_16x16x32_bf16 v[112:115], a[196:199], v[76:79], v[112:115]
v_cndmask_b32 v105, v105, v117, s[24:25]
v_mfma_f32_16x16x32_bf16 v[112:115], a[200:203], v[80:83], v[112:115]
v_cndmask_b32 v106, v106, v118, s[24:25]
v_mfma_f32_16x16x32_bf16 v[112:115], a[204:207], v[84:87], v[112:115]
v_cndmask_b32 v107, v107, v119, s[24:25]
v_mfma_f32_16x16x32_bf16 v[116:119], a[208:211], v[72:75], 0
v_cndmask_b32 v108, v108, v120, s[24:25]
v_mfma_f32_16x16x32_bf16 v[116:119], a[212:215], v[76:79], v[116:119]
v_cndmask_b32 v109, v109, v121, s[24:25]
v_mfma_f32_16x16x32_bf16 v[116:119], a[216:219], v[80:83], v[116:119]
v_cndmask_b32 v110, v110, v122, s[24:25]
v_mfma_f32_16x16x32_bf16 v[116:119], a[220:223], v[84:87], v[116:119]
v_cndmask_b32 v111, v111, v123, s[24:25]
v_mfma_f32_16x16x32_bf16 v[120:123], a[224:227], v[72:75], 0
v_cndmask_b32 v104, v104, v112, s[26:27]
v_mfma_f32_16x16x32_bf16 v[120:123], a[228:231], v[76:79], v[120:123]
v_cndmask_b32 v105, v105, v113, s[26:27]
v_mfma_f32_16x16x32_bf16 v[120:123], a[232:235], v[80:83], v[120:123]
v_cndmask_b32 v106, v106, v114, s[26:27]
v_mfma_f32_16x16x32_bf16 v[120:123], a[236:239], v[84:87], v[120:123]
v_cndmask_b32 v107, v107, v115, s[26:27]
v_mfma_f32_16x16x32_bf16 v[112:115], a[240:243], v[72:75], 0
v_cndmask_b32 v108, v108, v116, s[26:27]
v_mfma_f32_16x16x32_bf16 v[112:115], a[244:247], v[76:79], v[112:115]
v_cndmask_b32 v109, v109, v117, s[26:27]
v_mfma_f32_16x16x32_bf16 v[112:115], a[248:251], v[80:83], v[112:115]
v_cndmask_b32 v110, v110, v118, s[26:27]
v_mfma_f32_16x16x32_bf16 v[112:115], a[252:255], v[84:87], v[112:115]
v_cndmask_b32 v111, v111, v119, s[26:27]
v_cndmask_b32 v104, v104, v120, s[28:29]
v_cndmask_b32 v105, v105, v121, s[28:29]
v_cndmask_b32 v106, v106, v122, s[28:29]
v_cndmask_b32 v107, v107, v123, s[28:29]
s_nop 2
v_cndmask_b32 v108, v108, v112, s[28:29]
v_cndmask_b32 v109, v109, v113, s[28:29]
v_cndmask_b32 v110, v110, v114, s[28:29]
v_cndmask_b32 v111, v111, v115, s[28:29]
v_max3_f32 v124, v104, v105, v106
v_max3_f32 v4, v107, v108, v109
v_max3_f32 v124, v124, v110, v111
v_max_f32 v124, v124, v4
s_nop 1
v_max_f32_dpp v124, v124, v124 row_ror:2 row_mask:0xf bank_mask:0xf
s_nop 1
v_max_f32_dpp v124, v124, v124 row_ror:4 row_mask:0xf bank_mask:0xf
s_nop 1
v_max_f32_dpp v124, v124, v124 row_ror:8 row_mask:0xf bank_mask:0xf
v_mov_b32 v4, v124
s_nop 1
v_permlane32_swap_b32 v124, v4
v_max_f32 v124, v124, v4
v_mov_b32 v4, v124
s_nop 1
v_permlane16_swap_b32 v124, v4
v_max_f32 v124, v124, v4
v_mul_f32 v124, s34, v124
v_fma_f32 v104, v104, s34, -v124
v_fma_f32 v105, v105, s34, -v124
v_fma_f32 v106, v106, s34, -v124
v_fma_f32 v107, v107, s34, -v124
v_fma_f32 v108, v108, s34, -v124
v_fma_f32 v109, v109, s34, -v124
v_fma_f32 v110, v110, s34, -v124
v_fma_f32 v111, v111, s34, -v124
v_exp_f32 v104, v104
v_exp_f32 v105, v105
v_exp_f32 v106, v106
v_exp_f32 v107, v107
v_exp_f32 v108, v108
v_exp_f32 v109, v109
v_exp_f32 v110, v110
v_exp_f32 v111, v111
v_cvt_pk_bf16_f32 v112, v104, v105
v_cvt_pk_bf16_f32 v113, v106, v107
v_cvt_pk_bf16_f32 v114, v108, v109
v_cvt_pk_bf16_f32 v115, v110, v111
v_pk_add_f32 v[104:105], v[104:105], v[106:107]
v_pk_add_f32 v[108:109], v[108:109], v[110:111]
v_mov_b32_dpp v116, v112 row_ror:8 row_mask:0xf bank_mask:0xf
v_mov_b32_dpp v117, v113 row_ror:8 row_mask:0xf bank_mask:0xf
v_mov_b32_dpp v118, v114 row_ror:8 row_mask:0xf bank_mask:0xf
v_mov_b32_dpp v119, v115 row_ror:8 row_mask:0xf bank_mask:0xf
v_pk_add_f32 v[104:105], v[104:105], v[108:109]
v_add_f32 v125, v104, v105
s_waitcnt vmcnt(16)
v_xor_b32 v126, 0, v2
ds_read_b64_tr_b16 v[192:193], v126 offset:16384
ds_read_b64_tr_b16 v[194:195], v126 offset:16896
ds_read_b64_tr_b16 v[196:197], v126 offset:18432
ds_read_b64_tr_b16 v[198:199], v126 offset:18944
v_xor_b32 v127, 32, v2
ds_read_b64_tr_b16 v[200:201], v127 offset:16384
ds_read_b64_tr_b16 v[202:203], v127 offset:16896
ds_read_b64_tr_b16 v[204:205], v127 offset:18432
ds_read_b64_tr_b16 v[206:207], v127 offset:18944
v_xor_b32 v126, 64, v2
ds_read_b64_tr_b16 v[208:209], v126 offset:16384
ds_read_b64_tr_b16 v[210:211], v126 offset:16896
ds_read_b64_tr_b16 v[212:213], v126 offset:18432
ds_read_b64_tr_b16 v[214:215], v126 offset:18944
v_xor_b32 v127, 96, v2
ds_read_b64_tr_b16 v[216:217], v127 offset:16384
ds_read_b64_tr_b16 v[218:219], v127 offset:16896
ds_read_b64_tr_b16 v[220:221], v127 offset:18432
ds_read_b64_tr_b16 v[222:223], v127 offset:18944
v_xor_b32 v126, 128, v2
ds_read_b64_tr_b16 v[224:225], v126 offset:16384
ds_read_b64_tr_b16 v[226:227], v126 offset:16896
ds_read_b64_tr_b16 v[228:229], v126 offset:18432
ds_read_b64_tr_b16 v[230:231], v126 offset:18944
v_xor_b32 v127, 160, v2
ds_read_b64_tr_b16 v[232:233], v127 offset:16384
ds_read_b64_tr_b16 v[234:235], v127 offset:16896
ds_read_b64_tr_b16 v[236:237], v127 offset:18432
ds_read_b64_tr_b16 v[238:239], v127 offset:18944
v_xor_b32 v126, 192, v2
ds_read_b64_tr_b16 v[240:241], v126 offset:16384
ds_read_b64_tr_b16 v[242:243], v126 offset:16896
ds_read_b64_tr_b16 v[244:245], v126 offset:18432
ds_read_b64_tr_b16 v[246:247], v126 offset:18944
v_xor_b32 v127, 224, v2
ds_read_b64_tr_b16 v[248:249], v127 offset:16384
ds_read_b64_tr_b16 v[250:251], v127 offset:16896
ds_read_b64_tr_b16 v[252:253], v127 offset:18432
ds_read_b64_tr_b16 v[254:255], v127 offset:18944
s_waitcnt lgkmcnt(0)
v_xor_b32 v4, 0, v5
s_add_u32 s99, s35, 16384
s_mov_b32 m0, s99
s_add_u32 s99, s100, 49152
s_and_b32 s99, s99, 0xffff
buffer_load_dwordx4 v4, s[40:43], s99 offen offset:0 nt lds
buffer_load_dwordx4 v4, s[40:43], s99 offen offset:1024 nt lds
buffer_load_dwordx4 v4, s[40:43], s99 offen offset:2048 nt lds
buffer_load_dwordx4 v4, s[40:43], s99 offen offset:3072 nt lds
v_xor_b32 v4, 64, v5
s_add_u32 s99, s35, 20480
s_mov_b32 m0, s99
s_add_u32 s99, s100, 53248
s_and_b32 s99, s99, 0xffff
buffer_load_dwordx4 v4, s[40:43], s99 offen offset:0 nt lds
buffer_load_dwordx4 v4, s[40:43], s99 offen offset:1024 nt lds
buffer_load_dwordx4 v4, s[40:43], s99 offen offset:2048 nt lds
buffer_load_dwordx4 v4, s[40:43], s99 offen offset:3072 nt lds
v_xor_b32 v4, 128, v5
s_add_u32 s99, s35, 24576
s_mov_b32 m0, s99
s_add_u32 s99, s100, 57344
s_and_b32 s99, s99, 0xffff
buffer_load_dwordx4 v4, s[40:43], s99 offen offset:0 nt lds
buffer_load_dwordx4 v4, s[40:43], s99 offen offset:1024 nt lds
buffer_load_dwordx4 v4, s[40:43], s99 offen offset:2048 nt lds
buffer_load_dwordx4 v4, s[40:43], s99 offen offset:3072 nt lds
v_xor_b32 v4, 192, v5
s_add_u32 s99, s35, 28672
s_mov_b32 m0, s99
s_add_u32 s99, s100, 61440
s_and_b32 s99, s99, 0xffff
buffer_load_dwordx4 v4, s[40:43], s99 offen offset:0 nt lds
buffer_load_dwordx4 v4, s[40:43], s99 offen offset:1024 nt lds
buffer_load_dwordx4 v4, s[40:43], s99 offen offset:2048 nt lds
buffer_load_dwordx4 v4, s[40:43], s99 offen offset:3072 nt lds
v_smfmac_f32_16x16x64_bf16 v[40:43], v[112:115], v[128:135], v3
v_add_f32_dpp v125, v125, v125 row_ror:2 row_mask:0xf bank_mask:0xf
v_smfmac_f32_16x16x64_bf16 v[44:47], v[112:115], v[136:143], v3
s_nop 0
v_add_f32_dpp v125, v125, v125 row_ror:4 row_mask:0xf bank_mask:0xf
v_smfmac_f32_16x16x64_bf16 v[48:51], v[112:115], v[144:151], v3
s_nop 0
v_add_f32_dpp v125, v125, v125 row_ror:8 row_mask:0xf bank_mask:0xf
v_smfmac_f32_16x16x64_bf16 v[52:55], v[112:115], v[152:159], v3
v_mov_b32_dpp v120, v112 row_ror:12 row_mask:0xf bank_mask:0xf
v_smfmac_f32_16x16x64_bf16 v[56:59], v[112:115], v[160:167], v3
v_mov_b32_dpp v121, v113 row_ror:12 row_mask:0xf bank_mask:0xf
v_smfmac_f32_16x16x64_bf16 v[60:63], v[112:115], v[168:175], v3
v_mov_b32_dpp v122, v114 row_ror:12 row_mask:0xf bank_mask:0xf
v_smfmac_f32_16x16x64_bf16 v[64:67], v[112:115], v[176:183], v3
v_mov_b32_dpp v123, v115 row_ror:12 row_mask:0xf bank_mask:0xf
v_smfmac_f32_16x16x64_bf16 v[68:71], v[112:115], v[184:191], v3
s_nop 0
v_smfmac_f32_16x16x64_bf16 v[40:43], v[120:123], v[192:199], v3
v_mov_b32 v4, v125
v_smfmac_f32_16x16x64_bf16 v[44:47], v[120:123], v[200:207], v3
s_nop 0
v_permlane32_swap_b32 v125, v4
v_smfmac_f32_16x16x64_bf16 v[48:51], v[120:123], v[208:215], v3
v_add_f32 v125, v125, v4
v_smfmac_f32_16x16x64_bf16 v[52:55], v[120:123], v[216:223], v3
v_mov_b32 v4, v125
v_smfmac_f32_16x16x64_bf16 v[56:59], v[120:123], v[224:231], v3
s_nop 0
v_permlane16_swap_b32 v125, v4
v_smfmac_f32_16x16x64_bf16 v[60:63], v[120:123], v[232:239], v3
v_add_f32 v125, v125, v4
v_smfmac_f32_16x16x64_bf16 v[64:67], v[120:123], v[240:247], v3
v_smfmac_f32_16x16x64_bf16 v[68:71], v[120:123], v[248:255], v3
v_mov_b32_dpp v120, v112 row_ror:4 row_mask:0xf bank_mask:0xf
v_mov_b32_dpp v121, v113 row_ror:4 row_mask:0xf bank_mask:0xf
v_mov_b32_dpp v122, v114 row_ror:4 row_mask:0xf bank_mask:0xf
v_mov_b32_dpp v123, v115 row_ror:4 row_mask:0xf bank_mask:0xf
v_and_b32 v6, 1, v0
s_lshl_b32 s9, s3, 3
s_add_u32 s9, s9, 159744
v_lshlrev_b32 v6, 5, v6
v_add_u32 v6, s9, v6
ds_write_b64 v6, v[124:125]
s_lshl_b32 s10, s5, 2
s_add_u32 s10, s10, s3
s_lshl_b32 s10, s10, 8
s_add_u32 s52, s13, s10
s_add_u32 s93, s52, 221184
s_lshr_b32 s10, s10, 6
s_add_u32 s98, s13, s10
s_add_u32 s99, s98, 39680
s_add_u32 s98, s98, 39168
s_lshr_b32 s9, s5, 2
s_lshl_b32 s9, s9, 1
s_lshr_b32 s10, s3, 1
s_add_u32 s9, s9, s10
s_lshl_b32 s9, s9, 2
s_add_u32 s9, s9, s82
s_lshl_b32 s9, s9, 3
s_add_u32 s53, s9, s13
s_add_u32 s53, s53, 32768
s_lshl_b32 s9, s84, 2
s_add_u32 s9, s9, s3
s_lshl_b32 s10, s9, 12
s_add_u32 s54, s10, s13
s_lshl_b32 s10, s9, 6
s_add_u32 s55, s10, s13
s_add_u32 s55, s55, 32768
s_lshl_b32 s9, s83, 2
s_add_u32 s9, s9, s3
s_lshl_b32 s68, s9, 4
s_lshl_b32 s10, s4, 1
s_add_u32 s68, s68, s10
s_add_u32 s68, s68, s84
s_lshl_b32 s68, s68, 8
s_add_u32 s68, s68, 2097152
s_mul_i32 s0, s9, 24
s_mul_i32 s10, s4, 3
s_add_u32 s0, s0, s10
s_add_u32 s0, s0, s84
s_lshl_b32 s0, s0, 8
s_add_u32 s0, s0, 2244608
s_lshl_b32 s38, s9, 8
s_mul_i32 s10, s84, 18432
s_add_u32 s38, s38, s10
s_add_u32 s38, s38, s13
s_add_u32 s38, s38, 110592
s_mul_i32 s39, s84, 3072
s_lshl_b32 s10, s3, 10
s_add_u32 s39, s39, s10
s_add_u32 s39, s39, s13
s_add_u32 s39, s39, 110592
s_mul_i32 s36, s84, 1536
s_add_u32 s36, s36, s13
s_add_u32 s36, s36, 33280
s_lshr_b32 s92, s5, 3
s_mul_i32 s92, s92, 1536
s_add_u32 s92, s92, s13
s_add_u32 s92, s92, 98816
s_add_u32 s37, s13, 37888
s_sub_u32 s9, s5, 23
s_lshl_b32 s9, s9, 2
s_add_u32 s9, s9, s3
s_lshl_b32 s69, s9, 12
s_add_u32 s69, s69, 2097152
s_mul_i32 s1, s9, 6144
s_add_u32 s1, s1, 2244608
s_lshl_b32 s70, s9, 7
s_add_u32 s70, s70, s13
s_add_u32 s70, s70, 33280
s_lshr_b32 s10, s9, 1
s_lshl_b32 s10, s10, 6
s_and_b32 s9, s9, 1
s_lshl_b32 s9, s9, 3
s_add_u32 s71, s9, s10
s_add_u32 s71, s71, s37
s_lshl_b32 s89, s80, 12
s_add_u32 s89, s89, s13
s_add_u32 s89, s89, 221184
s_lshl_b32 s9, s81, 6
s_add_u32 s89, s89, s9
s_add_u32 s90, s89, 8192
s_add_u32 s91, s89, 16384
s_waitcnt vmcnt(16)
v_xor_b32 v126, 0, v2
ds_read_b64_tr_b16 v[88:89], v126 offset:0
ds_read_b64_tr_b16 v[90:91], v126 offset:512
ds_read_b64_tr_b16 v[92:93], v126 offset:2048
ds_read_b64_tr_b16 v[94:95], v126 offset:2560
v_xor_b32 v127, 32, v2
ds_read_b64_tr_b16 v[96:97], v127 offset:0
ds_read_b64_tr_b16 v[98:99], v127 offset:512
ds_read_b64_tr_b16 v[100:101], v127 offset:2048
ds_read_b64_tr_b16 v[102:103], v127 offset:2560
v_xor_b32 v126, 64, v2
ds_read_b64_tr_b16 v[72:73], v126 offset:0
ds_read_b64_tr_b16 v[74:75], v126 offset:512
ds_read_b64_tr_b16 v[76:77], v126 offset:2048
ds_read_b64_tr_b16 v[78:79], v126 offset:2560
v_xor_b32 v127, 96, v2
ds_read_b64_tr_b16 v[80:81], v127 offset:0
ds_read_b64_tr_b16 v[82:83], v127 offset:512
ds_read_b64_tr_b16 v[84:85], v127 offset:2048
ds_read_b64_tr_b16 v[86:87], v127 offset:2560
v_xor_b32 v126, 128, v2
ds_read_b64_tr_b16 v[104:105], v126 offset:0
ds_read_b64_tr_b16 v[106:107], v126 offset:512
ds_read_b64_tr_b16 v[108:109], v126 offset:2048
ds_read_b64_tr_b16 v[110:111], v126 offset:2560
s_waitcnt lgkmcnt(15)
v_smfmac_f32_16x16x64_bf16 v[40:43], v[116:119], v[88:95], v3
v_xor_b32 v127, 160, v2
ds_read_b64_tr_b16 v[88:89], v127 offset:0
ds_read_b64_tr_b16 v[90:91], v127 offset:512
ds_read_b64_tr_b16 v[92:93], v127 offset:2048
ds_read_b64_tr_b16 v[94:95], v127 offset:2560
s_waitcnt lgkmcnt(15)
v_smfmac_f32_16x16x64_bf16 v[44:47], v[116:119], v[96:103], v3
v_xor_b32 v126, 192, v2
ds_read_b64_tr_b16 v[96:97], v126 offset:0
ds_read_b64_tr_b16 v[98:99], v126 offset:512
ds_read_b64_tr_b16 v[100:101], v126 offset:2048
ds_read_b64_tr_b16 v[102:103], v126 offset:2560
s_waitcnt lgkmcnt(15)
v_smfmac_f32_16x16x64_bf16 v[48:51], v[116:119], v[72:79], v3
v_xor_b32 v127, 224, v2
ds_read_b64_tr_b16 v[72:73], v127 offset:0
ds_read_b64_tr_b16 v[74:75], v127 offset:512
ds_read_b64_tr_b16 v[76:77], v127 offset:2048
ds_read_b64_tr_b16 v[78:79], v127 offset:2560
s_waitcnt lgkmcnt(15)
v_smfmac_f32_16x16x64_bf16 v[52:55], v[116:119], v[80:87], v3
s_waitcnt lgkmcnt(12)
v_smfmac_f32_16x16x64_bf16 v[56:59], v[116:119], v[104:111], v3
s_waitcnt lgkmcnt(8)
v_smfmac_f32_16x16x64_bf16 v[60:63], v[116:119], v[88:95], v3
s_waitcnt lgkmcnt(4)
v_smfmac_f32_16x16x64_bf16 v[64:67], v[116:119], v[96:103], v3
s_waitcnt lgkmcnt(0)
v_smfmac_f32_16x16x64_bf16 v[68:71], v[116:119], v[72:79], v3
s_barrier
s_mul_i32 s85, s84, 1769472
s_mul_i32 s9, s4, 1152
s_add_u32 s85, s85, s9
s_lshl_b32 s9, s83, 7
s_add_u32 s85, s85, s9
v_lshrrev_b32 v126, 3, v0
v_and_b32 v127, 2, v126
v_xor_b32 v127, v127, v0
v_and_b32 v127, 7, v127
v_mul_u32_u24 v5, 9216, v126
v_lshl_add_u32 v5, v127, 4, v5
v_xor_b32 v6, 64, v5
s_mul_i32 s9, s3, 442368
s_add_u32 s9, s9, s85
s_mul_i32 s10, s3, 6144
s_add_u32 s10, s10, 131072
s_mov_b32 m0, s10
s_nop 0
buffer_load_dwordx4 v5, s[56:59], s9 offen  lds
s_add_u32 s9, s9, 73728
s_add_u32 s10, s10, 1024
s_mov_b32 m0, s10
s_nop 0
buffer_load_dwordx4 v6, s[56:59], s9 offen  lds
s_add_u32 s9, s9, 73728
s_add_u32 s10, s10, 1024
s_mov_b32 m0, s10
s_nop 0
buffer_load_dwordx4 v5, s[56:59], s9 offen  lds
s_add_u32 s9, s9, 73728
s_add_u32 s10, s10, 1024
s_mov_b32 m0, s10
s_nop 0
buffer_load_dwordx4 v6, s[56:59], s9 offen  lds
s_add_u32 s9, s9, 73728
s_add_u32 s10, s10, 1024
s_mov_b32 m0, s10
s_nop 0
buffer_load_dwordx4 v5, s[56:59], s9 offen  lds
s_add_u32 s9, s9, 73728
s_add_u32 s10, s10, 1024
s_mov_b32 m0, s10
s_nop 0
buffer_load_dwordx4 v6, s[56:59], s9 offen  lds
s_waitcnt vmcnt(6)
v_xor_b32 v126, 0, v2
ds_read_b64_tr_b16 v[80:81], v126 offset:16384
ds_read_b64_tr_b16 v[82:83], v126 offset:16896
ds_read_b64_tr_b16 v[84:85], v126 offset:18432
ds_read_b64_tr_b16 v[86:87], v126 offset:18944
v_xor_b32 v127, 32, v2
ds_read_b64_tr_b16 v[104:105], v127 offset:16384
ds_read_b64_tr_b16 v[106:107], v127 offset:16896
ds_read_b64_tr_b16 v[108:109], v127 offset:18432
ds_read_b64_tr_b16 v[110:111], v127 offset:18944
v_xor_b32 v126, 64, v2
ds_read_b64_tr_b16 v[88:89], v126 offset:16384
ds_read_b64_tr_b16 v[90:91], v126 offset:16896
ds_read_b64_tr_b16 v[92:93], v126 offset:18432
ds_read_b64_tr_b16 v[94:95], v126 offset:18944
v_xor_b32 v127, 96, v2
ds_read_b64_tr_b16 v[96:97], v127 offset:16384
ds_read_b64_tr_b16 v[98:99], v127 offset:16896
ds_read_b64_tr_b16 v[100:101], v127 offset:18432
ds_read_b64_tr_b16 v[102:103], v127 offset:18944
v_xor_b32 v126, 128, v2
ds_read_b64_tr_b16 v[72:73], v126 offset:16384
ds_read_b64_tr_b16 v[74:75], v126 offset:16896
ds_read_b64_tr_b16 v[76:77], v126 offset:18432
ds_read_b64_tr_b16 v[78:79], v126 offset:18944
s_waitcnt lgkmcnt(15)
v_smfmac_f32_16x16x64_bf16 v[40:43], v[120:123], v[80:87], v3
v_xor_b32 v127, 160, v2
ds_read_b64_tr_b16 v[80:81], v127 offset:16384
ds_read_b64_tr_b16 v[82:83], v127 offset:16896
ds_read_b64_tr_b16 v[84:85], v127 offset:18432
ds_read_b64_tr_b16 v[86:87], v127 offset:18944
s_waitcnt lgkmcnt(15)
v_smfmac_f32_16x16x64_bf16 v[44:47], v[120:123], v[104:111], v3
v_xor_b32 v126, 192, v2
ds_read_b64_tr_b16 v[104:105], v126 offset:16384
ds_read_b64_tr_b16 v[106:107], v126 offset:16896
ds_read_b64_tr_b16 v[108:109], v126 offset:18432
ds_read_b64_tr_b16 v[110:111], v126 offset:18944
s_waitcnt lgkmcnt(15)
v_smfmac_f32_16x16x64_bf16 v[48:51], v[120:123], v[88:95], v3
v_xor_b32 v127, 224, v2
ds_read_b64_tr_b16 v[88:89], v127 offset:16384
ds_read_b64_tr_b16 v[90:91], v127 offset:16896
ds_read_b64_tr_b16 v[92:93], v127 offset:18432
ds_read_b64_tr_b16 v[94:95], v127 offset:18944
s_waitcnt lgkmcnt(15)
v_smfmac_f32_16x16x64_bf16 v[52:55], v[120:123], v[96:103], v3
s_lshr_b32 s9, s3, 1
s_lshl_b32 s9, s9, 5
s_add_u32 s9, s9, 159744
v_mov_b32 v6, s9
ds_read_b128 v[96:99], v6
ds_read_b128 v[100:103], v6 offset:16
s_waitcnt lgkmcnt(14)
v_smfmac_f32_16x16x64_bf16 v[56:59], v[120:123], v[72:79], v3
s_waitcnt lgkmcnt(10)
v_smfmac_f32_16x16x64_bf16 v[60:63], v[120:123], v[80:87], v3
s_waitcnt lgkmcnt(6)
v_smfmac_f32_16x16x64_bf16 v[64:67], v[120:123], v[104:111], v3
s_waitcnt lgkmcnt(2)
v_smfmac_f32_16x16x64_bf16 v[68:71], v[120:123], v[88:95], v3
s_lshl_b32 s9, s3, 10
s_add_u32 s9, s9, 155648
v_lshlrev_b32 v126, 2, v0
v_add_u32 v5, s9, v126
s_mov_b64 exec, s[32:33]
v_pk_add_f32 v[40:41], v[40:41], v[42:43]
ds_write2_b32 v5, v40, v41 offset0:0 offset1:128
v_pk_add_f32 v[44:45], v[44:45], v[46:47]
ds_write2_b32 v5, v44, v45 offset0:16 offset1:144
v_pk_add_f32 v[48:49], v[48:49], v[50:51]
ds_write2_b32 v5, v48, v49 offset0:32 offset1:160
v_pk_add_f32 v[52:53], v[52:53], v[54:55]
ds_write2_b32 v5, v52, v53 offset0:48 offset1:176
v_pk_add_f32 v[56:57], v[56:57], v[58:59]
ds_write2_b32 v5, v56, v57 offset0:64 offset1:192
v_pk_add_f32 v[60:61], v[60:61], v[62:63]
ds_write2_b32 v5, v60, v61 offset0:80 offset1:208
v_pk_add_f32 v[64:65], v[64:65], v[66:67]
ds_write2_b32 v5, v64, v65 offset0:96 offset1:224
v_pk_add_f32 v[68:69], v[68:69], v[70:71]
ds_write2_b32 v5, v68, v69 offset0:112 offset1:240
s_mov_b64 exec, -1
s_branch L_epi
L_pair:
s_waitcnt lgkmcnt(0)
ds_read_b128 v[72:75], v6 offset:0
ds_read_b128 v[76:79], v6 offset:64
ds_read_b128 v[80:83], v6 offset:128
ds_read_b128 v[84:87], v6 offset:192
s_waitcnt lgkmcnt(3)
v_mfma_f32_16x16x32_bf16 v[112:115], a[0:3], v[72:75], 0
s_waitcnt lgkmcnt(2)
v_mfma_f32_16x16x32_bf16 v[112:115], a[4:7], v[76:79], v[112:115]
s_waitcnt lgkmcnt(1)
v_mfma_f32_16x16x32_bf16 v[112:115], a[8:11], v[80:83], v[112:115]
s_waitcnt lgkmcnt(0)
v_mfma_f32_16x16x32_bf16 v[112:115], a[12:15], v[84:87], v[112:115]
v_mfma_f32_16x16x32_bf16 v[116:119], a[16:19], v[72:75], 0
v_xor_b32 v126, 0, v2
v_mfma_f32_16x16x32_bf16 v[116:119], a[20:23], v[76:79], v[116:119]
ds_read_b64_tr_b16 v[88:89], v126 offset:0
v_mfma_f32_16x16x32_bf16 v[116:119], a[24:27], v[80:83], v[116:119]
ds_read_b64_tr_b16 v[90:91], v126 offset:512
v_mfma_f32_16x16x32_bf16 v[116:119], a[28:31], v[84:87], v[116:119]
ds_read_b64_tr_b16 v[92:93], v126 offset:2048
v_mfma_f32_16x16x32_bf16 v[120:123], a[32:35], v[72:75], 0
v_cndmask_b32 v104, v104, v112, s[14:15]
ds_read_b64_tr_b16 v[94:95], v126 offset:2560
v_mfma_f32_16x16x32_bf16 v[120:123], a[36:39], v[76:79], v[120:123]
v_cndmask_b32 v105, v105, v113, s[14:15]
v_xor_b32 v127, 32, v2
v_mfma_f32_16x16x32_bf16 v[120:123], a[40:43], v[80:83], v[120:123]
v_cndmask_b32 v106, v106, v114, s[14:15]
ds_read_b64_tr_b16 v[96:97], v127 offset:0
v_mfma_f32_16x16x32_bf16 v[120:123], a[44:47], v[84:87], v[120:123]
v_cndmask_b32 v107, v107, v115, s[14:15]
ds_read_b64_tr_b16 v[98:99], v127 offset:512
v_mfma_f32_16x16x32_bf16 v[112:115], a[48:51], v[72:75], 0
v_cndmask_b32 v108, v108, v116, s[14:15]
ds_read_b64_tr_b16 v[100:101], v127 offset:2048
v_mfma_f32_16x16x32_bf16 v[112:115], a[52:55], v[76:79], v[112:115]
v_cndmask_b32 v109, v109, v117, s[14:15]
ds_read_b64_tr_b16 v[102:103], v127 offset:2560
v_mfma_f32_16x16x32_bf16 v[112:115], a[56:59], v[80:83], v[112:115]
v_cndmask_b32 v110, v110, v118, s[14:15]
s_waitcnt vmcnt(0)
v_mfma_f32_16x16x32_bf16 v[112:115], a[60:63], v[84:87], v[112:115]
v_cndmask_b32 v111, v111, v119, s[14:15]
v_mov_b32 v40, 0
v_mfma_f32_16x16x32_bf16 v[116:119], a[64:67], v[72:75], 0
v_cndmask_b32 v104, v104, v120, s[16:17]
v_mov_b32 v41, 0
v_mfma_f32_16x16x32_bf16 v[116:119], a[68:71], v[76:79], v[116:119]
v_cndmask_b32 v105, v105, v121, s[16:17]
v_mov_b32 v42, 0
v_mfma_f32_16x16x32_bf16 v[116:119], a[72:75], v[80:83], v[116:119]
v_cndmask_b32 v106, v106, v122, s[16:17]
v_mov_b32 v43, 0
v_mfma_f32_16x16x32_bf16 v[116:119], a[76:79], v[84:87], v[116:119]
v_cndmask_b32 v107, v107, v123, s[16:17]
v_mov_b32 v44, 0
v_mfma_f32_16x16x32_bf16 v[120:123], a[80:83], v[72:75], 0
v_cndmask_b32 v108, v108, v112, s[16:17]
v_mov_b32 v45, 0
v_mfma_f32_16x16x32_bf16 v[120:123], a[84:87], v[76:79], v[120:123]
v_cndmask_b32 v109, v109, v113, s[16:17]
v_mov_b32 v46, 0
v_mfma_f32_16x16x32_bf16 v[120:123], a[88:91], v[80:83], v[120:123]
v_cndmask_b32 v110, v110, v114, s[16:17]
v_mov_b32 v47, 0
v_mfma_f32_16x16x32_bf16 v[120:123], a[92:95], v[84:87], v[120:123]
v_cndmask_b32 v111, v111, v115, s[16:17]
v_mov_b32 v48, 0
v_mfma_f32_16x16x32_bf16 v[112:115], a[96:99], v[72:75], 0
v_cndmask_b32 v104, v104, v116, s[18:19]
v_mov_b32 v49, 0
v_mfma_f32_16x16x32_bf16 v[112:115], a[100:103], v[76:79], v[112:115]
v_cndmask_b32 v105, v105, v117, s[18:19]
v_mov_b32 v50, 0
v_mfma_f32_16x16x32_bf16 v[112:115], a[104:107], v[80:83], v[112:115]
v_cndmask_b32 v106, v106, v118, s[18:19]
v_mov_b32 v51, 0
v_mfma_f32_16x16x32_bf16 v[112:115], a[108:111], v[84:87], v[112:115]
v_cndmask_b32 v107, v107, v119, s[18:19]
v_mfma_f32_16x16x32_bf16 v[116:119], a[112:115], v[72:75], 0
v_cndmask_b32 v108, v108, v120, s[18:19]
v_mfma_f32_16x16x32_bf16 v[116:119], a[116:119], v[76:79], v[116:119]
v_cndmask_b32 v109, v109, v121, s[18:19]
v_mfma_f32_16x16x32_bf16 v[116:119], a[120:123], v[80:83], v[116:119]
v_cndmask_b32 v110, v110, v122, s[18:19]
v_mfma_f32_16x16x32_bf16 v[116:119], a[124:127], v[84:87], v[116:119]
v_cndmask_b32 v111, v111, v123, s[18:19]
v_mfma_f32_16x16x32_bf16 v[120:123], a[128:131], v[72:75], 0
v_cndmask_b32 v104, v104, v112, s[20:21]
v_mfma_f32_16x16x32_bf16 v[120:123], a[132:135], v[76:79], v[120:123]
v_cndmask_b32 v105, v105, v113, s[20:21]
v_mfma_f32_16x16x32_bf16 v[120:123], a[136:139], v[80:83], v[120:123]
v_cndmask_b32 v106, v106, v114, s[20:21]
v_mfma_f32_16x16x32_bf16 v[120:123], a[140:143], v[84:87], v[120:123]
v_cndmask_b32 v107, v107, v115, s[20:21]
v_mfma_f32_16x16x32_bf16 v[112:115], a[144:147], v[72:75], 0
v_cndmask_b32 v108, v108, v116, s[20:21]
v_mfma_f32_16x16x32_bf16 v[112:115], a[148:151], v[76:79], v[112:115]
v_cndmask_b32 v109, v109, v117, s[20:21]
v_mfma_f32_16x16x32_bf16 v[112:115], a[152:155], v[80:83], v[112:115]
v_cndmask_b32 v110, v110, v118, s[20:21]
v_mfma_f32_16x16x32_bf16 v[112:115], a[156:159], v[84:87], v[112:115]
v_cndmask_b32 v111, v111, v119, s[20:21]
v_mfma_f32_16x16x32_bf16 v[116:119], a[160:163], v[72:75], 0
v_cndmask_b32 v104, v104, v120, s[22:23]
v_mfma_f32_16x16x32_bf16 v[116:119], a[164:167], v[76:79], v[116:119]
v_cndmask_b32 v105, v105, v121, s[22:23]
v_mfma_f32_16x16x32_bf16 v[116:119], a[168:171], v[80:83], v[116:119]
v_cndmask_b32 v106, v106, v122, s[22:23]
v_mfma_f32_16x16x32_bf16 v[116:119], a[172:175], v[84:87], v[116:119]
v_cndmask_b32 v107, v107, v123, s[22:23]
v_mfma_f32_16x16x32_bf16 v[120:123], a[176:179], v[72:75], 0
v_cndmask_b32 v108, v108, v112, s[22:23]
v_mfma_f32_16x16x32_bf16 v[120:123], a[180:183], v[76:79], v[120:123]
v_cndmask_b32 v109, v109, v113, s[22:23]
v_mfma_f32_16x16x32_bf16 v[120:123], a[184:187], v[80:83], v[120:123]
v_cndmask_b32 v110, v110, v114, s[22:23]
v_mfma_f32_16x16x32_bf16 v[120:123], a[188:191], v[84:87], v[120:123]
v_cndmask_b32 v111, v111, v115, s[22:23]
v_mfma_f32_16x16x32_bf16 v[112:115], a[192:195], v[72:75], 0
v_cndmask_b32 v104, v104, v116, s[24:25]
v_mfma_f32_16x16x32_bf16 v[112:115], a[196:199], v[76:79], v[112:115]
v_cndmask_b32 v105, v105, v117, s[24:25]
v_mfma_f32_16x16x32_bf16 v[112:115], a[200:203], v[80:83], v[112:115]
v_cndmask_b32 v106, v106, v118, s[24:25]
v_mfma_f32_16x16x32_bf16 v[112:115], a[204:207], v[84:87], v[112:115]
v_cndmask_b32 v107, v107, v119, s[24:25]
v_mfma_f32_16x16x32_bf16 v[116:119], a[208:211], v[72:75], 0
v_cndmask_b32 v108, v108, v120, s[24:25]
v_mfma_f32_16x16x32_bf16 v[116:119], a[212:215], v[76:79], v[116:119]
v_cndmask_b32 v109, v109, v121, s[24:25]
v_mfma_f32_16x16x32_bf16 v[116:119], a[216:219], v[80:83], v[116:119]
v_cndmask_b32 v110, v110, v122, s[24:25]
v_mfma_f32_16x16x32_bf16 v[116:119], a[220:223], v[84:87], v[116:119]
v_cndmask_b32 v111, v111, v123, s[24:25]
v_mfma_f32_16x16x32_bf16 v[120:123], a[224:227], v[72:75], 0
v_cndmask_b32 v104, v104, v112, s[26:27]
v_mfma_f32_16x16x32_bf16 v[120:123], a[228:231], v[76:79], v[120:123]
v_cndmask_b32 v105, v105, v113, s[26:27]
v_mfma_f32_16x16x32_bf16 v[120:123], a[232:235], v[80:83], v[120:123]
v_cndmask_b32 v106, v106, v114, s[26:27]
v_mfma_f32_16x16x32_bf16 v[120:123], a[236:239], v[84:87], v[120:123]
v_cndmask_b32 v107, v107, v115, s[26:27]
v_mfma_f32_16x16x32_bf16 v[112:115], a[240:243], v[72:75], 0
v_cndmask_b32 v108, v108, v116, s[26:27]
v_mfma_f32_16x16x32_bf16 v[112:115], a[244:247], v[76:79], v[112:115]
v_cndmask_b32 v109, v109, v117, s[26:27]
v_mfma_f32_16x16x32_bf16 v[112:115], a[248:251], v[80:83], v[112:115]
v_cndmask_b32 v110, v110, v118, s[26:27]
v_mfma_f32_16x16x32_bf16 v[112:115], a[252:255], v[84:87], v[112:115]
v_cndmask_b32 v111, v111, v119, s[26:27]
v_cndmask_b32 v104, v104, v120, s[28:29]
v_cndmask_b32 v105, v105, v121, s[28:29]
v_cndmask_b32 v106, v106, v122, s[28:29]
v_cndmask_b32 v107, v107, v123, s[28:29]
v_xor_b32 v126, 64, v2
ds_read_b64_tr_b16 v[72:73], v126 offset:0
ds_read_b64_tr_b16 v[74:75], v126 offset:512
ds_read_b64_tr_b16 v[76:77], v126 offset:2048
v_cndmask_b32 v108, v108, v112, s[28:29]
v_cndmask_b32 v109, v109, v113, s[28:29]
v_cndmask_b32 v110, v110, v114, s[28:29]
v_cndmask_b32 v111, v111, v115, s[28:29]
v_max3_f32 v124, v104, v105, v106
v_max3_f32 v4, v107, v108, v109
v_max3_f32 v124, v124, v110, v111
v_max_f32 v124, v124, v4
ds_read_b64_tr_b16 v[78:79], v126 offset:2560
v_xor_b32 v127, 96, v2
v_max_f32_dpp v124, v124, v124 row_ror:2 row_mask:0xf bank_mask:0xf
ds_read_b64_tr_b16 v[80:81], v127 offset:0
ds_read_b64_tr_b16 v[82:83], v127 offset:512
v_max_f32_dpp v124, v124, v124 row_ror:4 row_mask:0xf bank_mask:0xf
ds_read_b64_tr_b16 v[84:85], v127 offset:2048
ds_read_b64_tr_b16 v[86:87], v127 offset:2560
v_max_f32_dpp v124, v124, v124 row_ror:8 row_mask:0xf bank_mask:0xf
v_mov_b32 v4, v124
s_nop 1
v_permlane32_swap_b32 v124, v4
v_max_f32 v124, v124, v4
v_mov_b32 v4, v124
s_nop 1
v_permlane16_swap_b32 v124, v4
v_max_f32 v124, v124, v4
v_mul_f32 v124, s34, v124
v_fma_f32 v104, v104, s34, -v124
v_fma_f32 v105, v105, s34, -v124
v_fma_f32 v106, v106, s34, -v124
v_fma_f32 v107, v107, s34, -v124
v_fma_f32 v108, v108, s34, -v124
v_fma_f32 v109, v109, s34, -v124
v_fma_f32 v110, v110, s34, -v124
v_fma_f32 v111, v111, s34, -v124
v_exp_f32 v104, v104
v_exp_f32 v105, v105
v_exp_f32 v106, v106
v_exp_f32 v107, v107
v_exp_f32 v108, v108
v_exp_f32 v109, v109
v_exp_f32 v110, v110
v_exp_f32 v111, v111
v_cvt_pk_bf16_f32 v112, v104, v105
v_cvt_pk_bf16_f32 v113, v106, v107
v_cvt_pk_bf16_f32 v114, v108, v109
v_cvt_pk_bf16_f32 v115, v110, v111
v_pk_add_f32 v[104:105], v[104:105], v[106:107]
v_pk_add_f32 v[108:109], v[108:109], v[110:111]
v_smfmac_f32_16x16x64_bf16 v[40:43], v[112:115], v[128:135], v3
v_mov_b32_dpp v116, v112 row_ror:8 row_mask:0xf bank_mask:0xf
v_mov_b32_dpp v117, v113 row_ror:8 row_mask:0xf bank_mask:0xf
v_mov_b32_dpp v118, v114 row_ror:8 row_mask:0xf bank_mask:0xf
v_mov_b32_dpp v119, v115 row_ror:8 row_mask:0xf bank_mask:0xf
v_pk_add_f32 v[104:105], v[104:105], v[108:109]
v_add_f32 v125, v104, v105
v_xor_b32 v126, 128, v2
ds_read_b64_tr_b16 v[104:105], v126 offset:0
ds_read_b64_tr_b16 v[106:107], v126 offset:512
ds_read_b64_tr_b16 v[108:109], v126 offset:2048
ds_read_b64_tr_b16 v[110:111], v126 offset:2560
v_add_f32_dpp v125, v125, v125 row_ror:2 row_mask:0xf bank_mask:0xf
s_nop 1
v_add_f32_dpp v125, v125, v125 row_ror:4 row_mask:0xf bank_mask:0xf
s_waitcnt lgkmcnt(15)
v_smfmac_f32_16x16x64_bf16 v[40:43], v[116:119], v[88:95], v3
v_xor_b32 v127, 160, v2
ds_read_b64_tr_b16 v[88:89], v127 offset:0
ds_read_b64_tr_b16 v[90:91], v127 offset:512
ds_read_b64_tr_b16 v[92:93], v127 offset:2048
ds_read_b64_tr_b16 v[94:95], v127 offset:2560
v_smfmac_f32_16x16x64_bf16 v[44:47], v[112:115], v[136:143], v3
v_add_f32_dpp v125, v125, v125 row_ror:8 row_mask:0xf bank_mask:0xf
v_mov_b32_dpp v120, v112 row_ror:12 row_mask:0xf bank_mask:0xf
s_waitcnt lgkmcnt(15)
v_smfmac_f32_16x16x64_bf16 v[44:47], v[116:119], v[96:103], v3
v_xor_b32 v126, 192, v2
ds_read_b64_tr_b16 v[96:97], v126 offset:0
ds_read_b64_tr_b16 v[98:99], v126 offset:512
ds_read_b64_tr_b16 v[100:101], v126 offset:2048
ds_read_b64_tr_b16 v[102:103], v126 offset:2560
v_smfmac_f32_16x16x64_bf16 v[48:51], v[112:115], v[144:151], v3
v_mov_b32_dpp v121, v113 row_ror:12 row_mask:0xf bank_mask:0xf
v_mov_b32_dpp v122, v114 row_ror:12 row_mask:0xf bank_mask:0xf
s_waitcnt lgkmcnt(15)
v_smfmac_f32_16x16x64_bf16 v[48:51], v[116:119], v[72:79], v3
v_xor_b32 v127, 224, v2
ds_read_b64_tr_b16 v[72:73], v127 offset:0
ds_read_b64_tr_b16 v[74:75], v127 offset:512
ds_read_b64_tr_b16 v[76:77], v127 offset:2048
ds_read_b64_tr_b16 v[78:79], v127 offset:2560
v_smfmac_f32_16x16x64_bf16 v[52:55], v[112:115], v[152:159], v3
v_mov_b32_dpp v123, v115 row_ror:12 row_mask:0xf bank_mask:0xf
v_mov_b32 v4, v125
s_waitcnt lgkmcnt(15)
v_smfmac_f32_16x16x64_bf16 v[52:55], v[116:119], v[80:87], v3
v_xor_b32 v126, 0, v2
ds_read_b64_tr_b16 v[80:81], v126 offset:16384
ds_read_b64_tr_b16 v[82:83], v126 offset:16896
ds_read_b64_tr_b16 v[84:85], v126 offset:18432
ds_read_b64_tr_b16 v[86:87], v126 offset:18944
v_smfmac_f32_16x16x64_bf16 v[56:59], v[112:115], v[160:167], v3
v_permlane32_swap_b32 v125, v4
v_add_f32 v125, v125, v4
s_waitcnt lgkmcnt(15)
v_smfmac_f32_16x16x64_bf16 v[56:59], v[116:119], v[104:111], v3
v_xor_b32 v127, 32, v2
ds_read_b64_tr_b16 v[104:105], v127 offset:16384
ds_read_b64_tr_b16 v[106:107], v127 offset:16896
ds_read_b64_tr_b16 v[108:109], v127 offset:18432
ds_read_b64_tr_b16 v[110:111], v127 offset:18944
v_smfmac_f32_16x16x64_bf16 v[60:63], v[112:115], v[168:175], v3
v_mov_b32 v4, v125
s_nop 1
v_permlane16_swap_b32 v125, v4
s_waitcnt lgkmcnt(15)
v_smfmac_f32_16x16x64_bf16 v[60:63], v[116:119], v[88:95], v3
v_xor_b32 v126, 64, v2
ds_read_b64_tr_b16 v[88:89], v126 offset:16384
ds_read_b64_tr_b16 v[90:91], v126 offset:16896
ds_read_b64_tr_b16 v[92:93], v126 offset:18432
ds_read_b64_tr_b16 v[94:95], v126 offset:18944
v_smfmac_f32_16x16x64_bf16 v[64:67], v[112:115], v[176:183], v3
v_add_f32 v125, v125, v4
s_waitcnt lgkmcnt(15)
v_smfmac_f32_16x16x64_bf16 v[64:67], v[116:119], v[96:103], v3
v_xor_b32 v127, 96, v2
ds_read_b64_tr_b16 v[96:97], v127 offset:16384
ds_read_b64_tr_b16 v[98:99], v127 offset:16896
ds_read_b64_tr_b16 v[100:101], v127 offset:18432
ds_read_b64_tr_b16 v[102:103], v127 offset:18944
v_smfmac_f32_16x16x64_bf16 v[68:71], v[112:115], v[184:191], v3
v_and_b32 v6, 1, v0
s_lshl_b32 s9, s3, 3
s_add_u32 s9, s9, 159744
v_lshlrev_b32 v6, 5, v6
v_add_u32 v6, s9, v6
ds_write_b64 v6, v[124:125]
s_waitcnt lgkmcnt(15)
v_smfmac_f32_16x16x64_bf16 v[68:71], v[116:119], v[72:79], v3
v_xor_b32 v126, 128, v2
ds_read_b64_tr_b16 v[72:73], v126 offset:16384
ds_read_b64_tr_b16 v[74:75], v126 offset:16896
ds_read_b64_tr_b16 v[76:77], v126 offset:18432
ds_read_b64_tr_b16 v[78:79], v126 offset:18944
v_mov_b32_dpp v116, v112 row_ror:4 row_mask:0xf bank_mask:0xf
v_mov_b32_dpp v117, v113 row_ror:4 row_mask:0xf bank_mask:0xf
v_mov_b32_dpp v118, v114 row_ror:4 row_mask:0xf bank_mask:0xf
v_mov_b32_dpp v119, v115 row_ror:4 row_mask:0xf bank_mask:0xf
v_smfmac_f32_16x16x64_bf16 v[40:43], v[120:123], v[192:199], v3
s_waitcnt lgkmcnt(15)
v_smfmac_f32_16x16x64_bf16 v[40:43], v[116:119], v[80:87], v3
v_xor_b32 v127, 160, v2
ds_read_b64_tr_b16 v[80:81], v127 offset:16384
ds_read_b64_tr_b16 v[82:83], v127 offset:16896
ds_read_b64_tr_b16 v[84:85], v127 offset:18432
ds_read_b64_tr_b16 v[86:87], v127 offset:18944
v_smfmac_f32_16x16x64_bf16 v[44:47], v[120:123], v[200:207], v3
s_waitcnt lgkmcnt(15)
v_smfmac_f32_16x16x64_bf16 v[44:47], v[116:119], v[104:111], v3
v_xor_b32 v126, 192, v2
ds_read_b64_tr_b16 v[104:105], v126 offset:16384
ds_read_b64_tr_b16 v[106:107], v126 offset:16896
ds_read_b64_tr_b16 v[108:109], v126 offset:18432
ds_read_b64_tr_b16 v[110:111], v126 offset:18944
s_waitcnt lgkmcnt(12)
s_barrier
v_smfmac_f32_16x16x64_bf16 v[48:51], v[120:123], v[208:215], v3
s_waitcnt lgkmcnt(15)
v_smfmac_f32_16x16x64_bf16 v[48:51], v[116:119], v[88:95], v3
v_xor_b32 v127, 224, v2
ds_read_b64_tr_b16 v[88:89], v127 offset:16384
ds_read_b64_tr_b16 v[90:91], v127 offset:16896
ds_read_b64_tr_b16 v[92:93], v127 offset:18432
ds_read_b64_tr_b16 v[94:95], v127 offset:18944
v_smfmac_f32_16x16x64_bf16 v[52:55], v[120:123], v[216:223], v3
s_waitcnt lgkmcnt(15)
v_smfmac_f32_16x16x64_bf16 v[52:55], v[116:119], v[96:103], v3
s_lshr_b32 s9, s3, 1
s_lshl_b32 s9, s9, 5
s_add_u32 s9, s9, 159744
v_mov_b32 v6, s9
ds_read_b128 v[96:99], v6
ds_read_b128 v[100:103], v6 offset:16
v_smfmac_f32_16x16x64_bf16 v[56:59], v[120:123], v[224:231], v3
s_waitcnt lgkmcnt(14)
v_smfmac_f32_16x16x64_bf16 v[56:59], v[116:119], v[72:79], v3
v_smfmac_f32_16x16x64_bf16 v[60:63], v[120:123], v[232:239], v3
s_waitcnt lgkmcnt(10)
v_smfmac_f32_16x16x64_bf16 v[60:63], v[116:119], v[80:87], v3
v_smfmac_f32_16x16x64_bf16 v[64:67], v[120:123], v[240:247], v3
s_waitcnt lgkmcnt(6)
v_smfmac_f32_16x16x64_bf16 v[64:67], v[116:119], v[104:111], v3
v_smfmac_f32_16x16x64_bf16 v[68:71], v[120:123], v[248:255], v3
s_waitcnt lgkmcnt(2)
v_smfmac_f32_16x16x64_bf16 v[68:71], v[116:119], v[88:95], v3
s_lshl_b32 s9, s3, 10
s_add_u32 s9, s9, 155648
v_lshlrev_b32 v126, 2, v0
v_add_u32 v5, s9, v126
s_mov_b64 exec, s[32:33]
v_pk_add_f32 v[40:41], v[40:41], v[42:43]
ds_write2_b32 v5, v40, v41 offset0:0 offset1:128
v_pk_add_f32 v[44:45], v[44:45], v[46:47]
ds_write2_b32 v5, v44, v45 offset0:16 offset1:144
v_pk_add_f32 v[48:49], v[48:49], v[50:51]
ds_write2_b32 v5, v48, v49 offset0:32 offset1:160
v_pk_add_f32 v[52:53], v[52:53], v[54:55]
ds_write2_b32 v5, v52, v53 offset0:48 offset1:176
v_pk_add_f32 v[56:57], v[56:57], v[58:59]
ds_write2_b32 v5, v56, v57 offset0:64 offset1:192
v_pk_add_f32 v[60:61], v[60:61], v[62:63]
ds_write2_b32 v5, v60, v61 offset0:80 offset1:208
v_pk_add_f32 v[64:65], v[64:65], v[66:67]
ds_write2_b32 v5, v64, v65 offset0:96 offset1:224
v_pk_add_f32 v[68:69], v[68:69], v[70:71]
ds_write2_b32 v5, v68, v69 offset0:112 offset1:240
s_mov_b64 exec, -1
L_epi:
s_waitcnt lgkmcnt(8)
v_max3_f32 v84, v96, v98, v100
v_max_f32 v84, v84, v102
v_sub_f32 v96, v96, v84
v_sub_f32 v98, v98, v84
v_sub_f32 v100, v100, v84
v_sub_f32 v102, v102, v84
v_exp_f32 v96, v96
v_exp_f32 v98, v98
v_exp_f32 v100, v100
v_exp_f32 v102, v102
v_mul_f32 v85, v96, v97
v_fmac_f32 v85, v98, v99
v_fmac_f32 v85, v100, v101
v_fmac_f32 v85, v102, v103
s_lshl_b32 s9, s3, 8
s_add_u32 s9, s9, 155648
v_add_u32 v5, s9, v126
v_mov_b32 v127, 0
s_waitcnt lgkmcnt(0)
s_barrier
ds_read2st64_b32 v[80:81], v5 offset0:0 offset1:4
ds_read2st64_b32 v[82:83], v5 offset0:8 offset1:12
v_lshlrev_b32 v5, 4, v0
v_and_b32 v6, 32, v0
s_waitcnt lgkmcnt(1)
v_mul_f32 v86, v96, v80
v_fmac_f32 v86, v98, v81
s_waitcnt lgkmcnt(0)
v_fmac_f32 v86, v100, v82
v_fmac_f32 v86, v102, v83
s_cmp_lg_u32 s7, 0
s_cbranch_scc1 Lslow11
buffer_store_dword v86, v126, s[44:47], s52 offen
s_mov_b64 exec, 1
buffer_store_dwordx2 v[84:85], v127, s[44:47], s53 offen
s_mov_b64 exec, -1
Lback12:
s_cmp_ge_u32 s5, 18
s_cbranch_scc1 LnoS213
buffer_load_dwordx4 v[64:67], v6, s[44:47], s55 offen sc1
buffer_load_dwordx4 v[68:71], v6, s[44:47], s55 offen offset:16 sc1
buffer_load_dwordx4 v[72:75], v5, s[44:47], s54 offen offset:0 sc1
buffer_load_dwordx4 v[76:79], v5, s[44:47], s54 offen offset:1024 sc1
buffer_load_dwordx4 v[80:83], v5, s[44:47], s54 offen offset:2048 sc1
buffer_load_dwordx4 v[84:87], v5, s[44:47], s54 offen offset:3072 sc1
v_lshlrev_b32 v100, 3, v0
s_mul_i32 s10, s3, 544
s_add_u32 s10, s10, 159808
v_add_u32 v100, s10, v100
v_and_b32 v101, 3, v0
v_mul_u32_u24 v101, 544, v101
v_lshrrev_b32 v4, 4, v0
v_lshl_add_u32 v101, v4, 4, v101
v_add_u32 v101, 159808, v101
v_and_b32 v102, 15, v0
v_lshlrev_b32 v102, 4, v102
v_lshrrev_b32 v4, 4, v0
v_lshl_add_u32 v102, v4, 6, v102
s_lshl_b32 s9, s3, 5
v_xor_b32 v103, s9, v1
v_add_u32 v103, 131072, v103
s_mul_i32 s85, s84, 1769472
s_mul_i32 s9, s4, 1152
s_add_u32 s85, s85, s9
s_lshl_b32 s9, s83, 7
s_add_u32 s85, s85, s9
Lc15:
s_waitcnt vmcnt(5)
v_max3_u32 v4, v64, v65, v66
s_waitcnt vmcnt(4)
v_max3_u32 v4, v4, v67, v68
v_max3_u32 v4, v4, v69, v70
v_max_u32 v4, v4, v71
v_max3_f32 v88, v64, v66, v68
v_max_f32 v88, v88, v70
v_sub_f32 v104, v64, v88
v_sub_f32 v106, v66, v88
v_sub_f32 v108, v68, v88
v_sub_f32 v110, v70, v88
v_exp_f32 v104, v104
v_exp_f32 v106, v106
v_exp_f32 v108, v108
v_exp_f32 v110, v110
v_mul_f32 v89, v104, v65
v_fmac_f32 v89, v106, v67
v_fmac_f32 v89, v108, v69
v_fmac_f32 v89, v110, v71
v_rcp_f32 v89, v89
s_nop 0
v_mul_f32 v104, v104, v89
v_mul_f32 v106, v106, v89
v_mul_f32 v108, v108, v89
v_mul_f32 v110, v110, v89
s_waitcnt vmcnt(3)
v_max3_u32 v4, v4, v72, v73
v_max3_u32 v4, v4, v74, v75
s_waitcnt vmcnt(2)
v_max3_u32 v4, v4, v76, v77
v_max3_u32 v4, v4, v78, v79
s_waitcnt vmcnt(1)
v_max3_u32 v4, v4, v80, v81
v_max3_u32 v4, v4, v82, v83
s_waitcnt vmcnt(0)
v_max3_u32 v4, v4, v84, v85
v_max3_u32 v4, v4, v86, v87
v_cmp_eq_u32 vcc, -1, v4
s_cbranch_vccnz Lr16
Lo17:
v_pk_mul_f32 v[90:91], v[72:73], v[104:105] op_sel_hi:[1,0]
v_pk_mul_f32 v[92:93], v[74:75], v[104:105] op_sel_hi:[1,0]
v_pk_fma_f32 v[90:91], v[76:77], v[106:107], v[90:91] op_sel_hi:[1,0,1]
v_pk_fma_f32 v[92:93], v[78:79], v[106:107], v[92:93] op_sel_hi:[1,0,1]
v_pk_fma_f32 v[90:91], v[80:81], v[108:109], v[90:91] op_sel_hi:[1,0,1]
v_pk_fma_f32 v[92:93], v[82:83], v[108:109], v[92:93] op_sel_hi:[1,0,1]
v_pk_fma_f32 v[90:91], v[84:85], v[110:111], v[90:91] op_sel_hi:[1,0,1]
v_pk_fma_f32 v[92:93], v[86:87], v[110:111], v[92:93] op_sel_hi:[1,0,1]
v_cvt_pk_bf16_f32 v90, v90, v91
v_cvt_pk_bf16_f32 v91, v92, v93
ds_write_b64 v100, v[90:91]
s_waitcnt vmcnt(0) lgkmcnt(0)
s_barrier
ds_read_b128 v[64:67], v101 offset:0
ds_read_b128 v[68:71], v101 offset:64
ds_read_b128 v[72:75], v101 offset:128
ds_read_b128 v[76:79], v101 offset:192
ds_read_b128 v[80:83], v101 offset:256
ds_read_b128 v[84:87], v101 offset:320
ds_read_b128 v[88:91], v101 offset:384
ds_read_b128 v[92:95], v101 offset:448
s_waitcnt lgkmcnt(7)
v_mfma_f32_16x16x32_bf16 v[96:99], v[8:11], v[64:67], 0
ds_read_b64_tr_b16 v[40:41], v103 offset:0
s_waitcnt lgkmcnt(7)
v_mfma_f32_16x16x32_bf16 v[96:99], v[12:15], v[68:71], v[96:99]
ds_read_b64_tr_b16 v[42:43], v103 offset:512
s_waitcnt lgkmcnt(7)
v_mfma_f32_16x16x32_bf16 v[96:99], v[16:19], v[72:75], v[96:99]
ds_read_b64_tr_b16 v[44:45], v103 offset:4096
s_waitcnt lgkmcnt(7)
v_mfma_f32_16x16x32_bf16 v[96:99], v[20:23], v[76:79], v[96:99]
ds_read_b64_tr_b16 v[46:47], v103 offset:4608
s_waitcnt lgkmcnt(7)
v_mfma_f32_16x16x32_bf16 v[96:99], v[24:27], v[80:83], v[96:99]
ds_read_b64_tr_b16 v[48:49], v103 offset:8192
s_waitcnt lgkmcnt(7)
v_mfma_f32_16x16x32_bf16 v[96:99], v[28:31], v[84:87], v[96:99]
ds_read_b64_tr_b16 v[50:51], v103 offset:8704
s_waitcnt lgkmcnt(7)
v_mfma_f32_16x16x32_bf16 v[96:99], v[32:35], v[88:91], v[96:99]
s_waitcnt lgkmcnt(6)
v_mfma_f32_16x16x32_bf16 v[96:99], v[36:39], v[92:95], v[96:99]
ds_read_b64_tr_b16 v[52:53], v103 offset:12288
ds_read_b64_tr_b16 v[54:55], v103 offset:12800
ds_read_b64_tr_b16 v[56:57], v103 offset:16384
ds_read_b64_tr_b16 v[58:59], v103 offset:16896
ds_read_b64_tr_b16 v[60:61], v103 offset:20480
ds_read_b64_tr_b16 v[62:63], v103 offset:20992
s_mov_b64 exec, s[30:31]
s_nop 0
buffer_store_dwordx4 v[96:99], v102, s[44:47], s68 offen sc1
s_cmp_lg_u32 s7, 0
s_cbranch_scc1 Lslow18
s_mov_b64 exec, 1
buffer_store_dword v0, v0, s[44:47], s98 offen
Lback19:
s_mov_b64 exec, -1
LnoS2b14:
s_waitcnt lgkmcnt(0)
s_barrier
v_lshrrev_b32 v5, 3, v0
v_and_b32 v6, 2, v5
v_xor_b32 v6, v6, v0
v_and_b32 v6, 7, v6
v_mul_u32_u24 v124, 9216, v5
v_lshl_add_u32 v124, v6, 4, v124
v_xor_b32 v125, 64, v124
s_mul_i32 s9, s3, 442368
s_add_u32 s9, s9, s85
s_mul_i32 s10, s3, 6144
s_add_u32 s10, s10, 131072
s_mov_b32 m0, s10
s_nop 0
buffer_load_dwordx4 v124, s[60:63], s9 offen  lds
s_add_u32 s9, s9, 73728
s_add_u32 s10, s10, 1024
s_mov_b32 m0, s10
s_nop 0
buffer_load_dwordx4 v125, s[60:63], s9 offen  lds
s_add_u32 s9, s9, 73728
s_add_u32 s10, s10, 1024
s_mov_b32 m0, s10
s_nop 0
buffer_load_dwordx4 v124, s[60:63], s9 offen  lds
s_add_u32 s9, s9, 73728
s_add_u32 s10, s10, 1024
s_mov_b32 m0, s10
s_nop 0
buffer_load_dwordx4 v125, s[60:63], s9 offen  lds
s_add_u32 s9, s9, 73728
s_add_u32 s10, s10, 1024
s_mov_b32 m0, s10
s_nop 0
buffer_load_dwordx4 v124, s[60:63], s9 offen  lds
s_add_u32 s9, s9, 73728
s_add_u32 s10, s10, 1024
s_mov_b32 m0, s10
s_nop 0
buffer_load_dwordx4 v125, s[60:63], s9 offen  lds
s_mul_i32 s85, s4, 3
s_add_u32 s85, s85, s84
s_mul_i32 s85, s85, 221184
s_lshl_b32 s9, s83, 7
s_add_u32 s85, s85, s9
s_mul_i32 s9, s3, 55296
s_add_u32 s9, s9, s85
v_min_u32 v5, 47, v0
v_mul_u32_u24 v5, 1152, v5
s_mov_b32 m0, 162816
s_nop 0
buffer_load_dword v5, s[64:67], s9 offen  lds
v_and_b32 v4, 15, v0
v_cmp_eq_u32 vcc, 4, v4
v_mov_b32 v4, 0x3f803f80
s_nop 0
v_cndmask_b32 v88, 0, v4, vcc
v_mov_b32 v89, v88
v_mov_b32 v90, v88
v_mov_b32 v91, v88
v_mov_b32 v92, v88
v_mov_b32 v93, v88
v_mov_b32 v94, v88
v_mov_b32 v95, v88
v_mov_b32 v96, v88
v_mov_b32 v97, v88
v_mov_b32 v98, v88
v_mov_b32 v99, v88
v_mov_b32 v100, v88
v_mov_b32 v101, v88
v_mov_b32 v102, v88
v_mov_b32 v103, v88
v_mov_b32 v104, v88
v_mov_b32 v105, v88
v_mov_b32 v106, v88
v_mov_b32 v107, v88
v_mov_b32 v108, v88
v_mov_b32 v109, v88
v_mov_b32 v110, v88
v_mov_b32 v111, v88
v_mov_b32 v116, 0
v_mov_b32 v117, 0
v_mov_b32 v118, 0
v_mov_b32 v119, 0
s_waitcnt vmcnt(1)
s_barrier
s_lshl_b32 s9, s3, 5
v_xor_b32 v5, s9, v1
v_add_u32 v5, 131072, v5
ds_read_b64_tr_b16 v[64:65], v5 offset:0
ds_read_b64_tr_b16 v[66:67], v5 offset:512
ds_read_b64_tr_b16 v[68:69], v5 offset:4096
ds_read_b64_tr_b16 v[70:71], v5 offset:4608
ds_read_b64_tr_b16 v[72:73], v5 offset:8192
ds_read_b64_tr_b16 v[74:75], v5 offset:8704
ds_read_b64_tr_b16 v[76:77], v5 offset:12288
ds_read_b64_tr_b16 v[78:79], v5 offset:12800
ds_read_b64_tr_b16 v[80:81], v5 offset:16384
ds_read_b64_tr_b16 v[82:83], v5 offset:16896
ds_read_b64_tr_b16 v[84:85], v5 offset:20480
ds_read_b64_tr_b16 v[86:87], v5 offset:20992
s_waitcnt lgkmcnt(0)
s_barrier
v_lshrrev_b32 v5, 3, v0
v_and_b32 v6, 2, v5
v_xor_b32 v6, v6, v0
v_and_b32 v6, 7, v6
v_mul_u32_u24 v124, 1152, v5
v_lshl_add_u32 v124, v6, 4, v124
v_xor_b32 v125, 64, v124
s_mul_i32 s9, s3, 55296
s_add_u32 s9, s9, s85
s_mul_i32 s10, s3, 6144
s_add_u32 s10, s10, 131072
s_mov_b32 m0, s10
s_nop 0
buffer_load_dwordx4 v124, s[64:67], s9 offen  lds
s_add_u32 s9, s9, 9216
s_add_u32 s10, s10, 1024
s_mov_b32 m0, s10
s_nop 0
buffer_load_dwordx4 v125, s[64:67], s9 offen  lds
s_add_u32 s9, s9, 9216
s_add_u32 s10, s10, 1024
s_mov_b32 m0, s10
s_nop 0
buffer_load_dwordx4 v124, s[64:67], s9 offen  lds
s_add_u32 s9, s9, 9216
s_add_u32 s10, s10, 1024
s_mov_b32 m0, s10
s_nop 0
buffer_load_dwordx4 v125, s[64:67], s9 offen  lds
s_add_u32 s9, s9, 9216
s_add_u32 s10, s10, 1024
s_mov_b32 m0, s10
s_nop 0
buffer_load_dwordx4 v124, s[64:67], s9 offen  lds
s_add_u32 s9, s9, 9216
s_add_u32 s10, s10, 1024
s_mov_b32 m0, s10
s_nop 0
buffer_load_dwordx4 v125, s[64:67], s9 offen  lds
LnoM20:
s_cmp_lt_u32 s5, 23
s_cbranch_scc1 LnoR21
s_add_u32 s11, s69, 4096
v_lshlrev_b32 v38, 4, v0
v_and_b32 v39, 3, v0
v_lshlrev_b32 v37, 4, v39
v_bfe_u32 v4, v0, 3, 1
v_lshl_add_u32 v36, v4, 6, v37
v_bfe_u32 v4, v0, 2, 1
v_lshl_add_u32 v36, v4, 3, v36
v_lshrrev_b32 v4, 5, v0
v_lshl_add_u32 v37, v4, 2, v37
s_cmp_eq_u32 s6, 0
s_cbranch_scc1 Lh22
s_mul_i32 s12, s6, 206592
s_add_u32 s12, s12, s13
s_add_u32 s12, s12, 39168
v_mov_b32 v12, 0
v_mov_b32 v13, 0
v_mov_b32 v14, 0
v_mov_b32 v15, 0
s_mov_b64 exec, 0x3ffff
buffer_load_dwordx4 v[12:15], v38, s[44:47], s12 offen sc1
s_mov_b64 exec, -1
Lc23:
s_waitcnt vmcnt(0)
v_max3_u32 v4, v12, v13, v14
v_max_u32 v4, v4, v15
v_cmp_eq_u32 vcc, -1, v4
s_cbranch_vccnz Lr24
Lo25:
Lh22:
buffer_load_dwordx4 v[12:15], v38, s[44:47], s69 offen offset:0 sc1
buffer_load_dwordx4 v[16:19], v38, s[44:47], s69 offen offset:1024 sc1
buffer_load_dwordx4 v[20:23], v38, s[44:47], s69 offen offset:2048 sc1
buffer_load_dwordx4 v[24:27], v38, s[44:47], s69 offen offset:3072 sc1
Lc26:
s_waitcnt vmcnt(3)
v_max3_u32 v4, v12, v13, v14
s_waitcnt vmcnt(2)
v_max3_u32 v4, v4, v15, v16
v_max3_u32 v4, v4, v17, v18
s_waitcnt vmcnt(1)
v_max3_u32 v4, v4, v19, v20
v_max3_u32 v4, v4, v21, v22
s_waitcnt vmcnt(0)
v_max3_u32 v4, v4, v23, v24
v_max3_u32 v4, v4, v25, v26
v_max_u32 v4, v4, v27
v_cmp_eq_u32 vcc, -1, v4
s_cbranch_vccnz Lr27
Lo28:
v_pk_add_f32 v[120:121], v[12:13], v[16:17]
v_pk_add_f32 v[122:123], v[14:15], v[18:19]
v_pk_add_f32 v[124:125], v[20:21], v[24:25]
v_pk_add_f32 v[126:127], v[22:23], v[26:27]
v_pk_add_f32 v[120:121], v[120:121], v[124:125]
v_pk_add_f32 v[122:123], v[122:123], v[126:127]
s_nop 1
v_permlane32_swap_b32 v120, v122
v_permlane32_swap_b32 v121, v123
v_pk_add_f32 v[120:121], v[120:121], v[122:123]
s_nop 1
v_permlane16_swap_b32 v120, v121
v_add_f32 v120, v120, v121
v_add_f32 v120, v120, v8
v_cvt_pk_bf16_f32 v120, v120, v120
v_and_b32 v8, 0xffff0000, v120
v_mov_b32 v121, v8
v_mov_b32 v122, v8
v_mov_b32 v126, v8
v_mul_f32 v127, v8, v8
v_permlane16_swap_b32 v121, v122
s_nop 0
v_permlane32_swap_b32 v126, v127
v_cvt_pk_bf16_f32 v124, v121, v122
v_add_f32 v126, v126, v127
v_mov_b32 v125, v124
s_nop 0
v_add_f32_dpp v126, v126, v126 row_ror:4 row_mask:0xf bank_mask:0xf
v_permlane32_swap_b32 v124, v125
s_nop 0
v_add_f32_dpp v126, v126, v126 row_ror:8 row_mask:0xf bank_mask:0xf
v_mov_b32 v127, v126
s_nop 1
v_permlane16_swap_b32 v126, v127
v_add_f32 v126, v126, v127
s_cmp_lg_u32 s7, 0
s_cbranch_scc1 Lslow29
s_mov_b64 exec, s[32:33]
buffer_store_dwordx2 v[124:125], v36, s[44:47], s70 offen
s_mov_b32 exec_lo, 15
s_mov_b32 exec_hi, 15
buffer_store_dword v126, v37, s[44:47], s71 offen
s_mov_b64 exec, -1
Lback30:
s_add_u32 s70, s70, 65536
s_add_u32 s71, s71, 65536
LnoR21:
s_cmp_ge_u32 s5, 27
s_cbranch_scc1 LnoS4531
s_add_u32 s85, s39, 9216
s_add_u32 s86, s39, 18432
s_add_u32 s87, s39, 27648
s_add_u32 s88, s39, 36864
s_add_u32 s12, s39, 46080
s_add_u32 s11, s38, 9216
v_and_b32 v6, 15, v0
v_lshlrev_b32 v6, 4, v6
v_lshrrev_b32 v4, 4, v0
v_lshl_add_u32 v6, v4, 6, v6
v_lshlrev_b32 v5, 4, v0
s_mov_b64 exec, 0xff
buffer_load_dwordx4 v[116:119], v5, s[44:47], s37 offen offset:1024 sc1
s_mov_b64 exec, -1
buffer_load_dwordx4 v[112:115], v5, s[44:47], s37 offen sc1
s_mov_b64 exec, s[30:31]
buffer_load_dwordx4 v[88:91], v6, s[44:47], s36 offen offset:0 sc1
buffer_load_dwordx4 v[92:95], v6, s[44:47], s36 offen offset:256 sc1
buffer_load_dwordx4 v[96:99], v6, s[44:47], s36 offen offset:512 sc1
buffer_load_dwordx4 v[100:103], v6, s[44:47], s36 offen offset:768 sc1
buffer_load_dwordx4 v[104:107], v6, s[44:47], s36 offen offset:1024 sc1
buffer_load_dwordx4 v[108:111], v6, s[44:47], s36 offen offset:1280 sc1
s_mov_b64 exec, -1
Lc32:
s_waitcnt vmcnt(7)
v_max3_u32 v4, v116, v117, v118
s_waitcnt vmcnt(6)
v_max3_u32 v4, v4, v119, v112
v_max3_u32 v4, v4, v113, v114
s_waitcnt vmcnt(5)
v_max3_u32 v4, v4, v115, v88
v_max3_u32 v4, v4, v89, v90
s_waitcnt vmcnt(4)
v_max3_u32 v4, v4, v91, v92
v_max3_u32 v4, v4, v93, v94
s_waitcnt vmcnt(3)
v_max3_u32 v4, v4, v95, v96
v_max3_u32 v4, v4, v97, v98
s_waitcnt vmcnt(2)
v_max3_u32 v4, v4, v99, v100
v_max3_u32 v4, v4, v101, v102
s_waitcnt vmcnt(1)
v_max3_u32 v4, v4, v103, v104
v_max3_u32 v4, v4, v105, v106
s_waitcnt vmcnt(0)
v_max3_u32 v4, v4, v107, v108
v_max3_u32 v4, v4, v109, v110
v_max_u32 v4, v4, v111
v_cmp_eq_u32 vcc, -1, v4
s_cbranch_vccnz Lr33
Lo34:
v_mfma_f32_16x16x32_bf16 v[120:123], v[40:43], v[88:91], 0
v_add_f32 v4, v112, v114
v_mfma_f32_16x16x32_bf16 v[124:127], v[64:67], v[88:91], 0
v_add_f32 v5, v113, v115
v_add_f32 v4, v4, v116
v_mfma_f32_16x16x32_bf16 v[120:123], v[44:47], v[92:95], v[120:123]
v_add_f32 v5, v5, v117
v_add_f32 v4, v4, v118
v_mfma_f32_16x16x32_bf16 v[124:127], v[68:71], v[92:95], v[124:127]
v_add_f32 v5, v5, v119
v_mfma_f32_16x16x32_bf16 v[120:123], v[48:51], v[96:99], v[120:123]
s_nop 0
v_permlane32_swap_b32 v4, v5
v_add_f32 v4, v4, v5
v_mfma_f32_16x16x32_bf16 v[124:127], v[72:75], v[96:99], v[124:127]
s_nop 0
v_add_f32_dpp v4, v4, v4 row_ror:4 row_mask:0xf bank_mask:0xf
v_mfma_f32_16x16x32_bf16 v[120:123], v[52:55], v[100:103], v[120:123]
s_nop 0
v_add_f32_dpp v4, v4, v4 row_ror:8 row_mask:0xf bank_mask:0xf
v_mov_b32 v5, v4
v_mfma_f32_16x16x32_bf16 v[124:127], v[76:79], v[100:103], v[124:127]
s_nop 0
v_permlane16_swap_b32 v4, v5
v_add_f32 v4, v4, v5
v_mfma_f32_16x16x32_bf16 v[120:123], v[56:59], v[104:107], v[120:123]
v_mov_b32 v5, v4
v_mfma_f32_16x16x32_bf16 v[124:127], v[80:83], v[104:107], v[124:127]
s_nop 0
v_permlane32_swap_b32 v4, v5
v_mul_f32 v4, 0xbae38e39, v4
v_mfma_f32_16x16x32_bf16 v[120:123], v[60:63], v[108:111], v[120:123]
v_mul_f32 v5, 0x3ae38e39, v5
v_fma_f32 v5, -v4, v4, v5
v_mfma_f32_16x16x32_bf16 v[124:127], v[84:87], v[108:111], v[124:127]
v_max_f32 v5, 0, v5
v_add_f32 v5, 0x3727c5ac, v5
v_rsq_f32 v5, v5
s_nop 1
v_fmac_f32_dpp v120, v120, v4 row_newbcast:4 row_mask:0xf bank_mask:0xf
v_fmac_f32_dpp v121, v121, v4 row_newbcast:4 row_mask:0xf bank_mask:0xf
v_fmac_f32_dpp v122, v122, v4 row_newbcast:4 row_mask:0xf bank_mask:0xf
v_fmac_f32_dpp v123, v123, v4 row_newbcast:4 row_mask:0xf bank_mask:0xf
v_fmac_f32_dpp v124, v124, v4 row_newbcast:4 row_mask:0xf bank_mask:0xf
v_fmac_f32_dpp v125, v125, v4 row_newbcast:4 row_mask:0xf bank_mask:0xf
v_fmac_f32_dpp v126, v126, v4 row_newbcast:4 row_mask:0xf bank_mask:0xf
v_fmac_f32_dpp v127, v127, v4 row_newbcast:4 row_mask:0xf bank_mask:0xf
v_pk_mul_f32 v[120:121], v[120:121], v[4:5] op_sel:[0,1] op_sel_hi:[1,1]
v_pk_mul_f32 v[122:123], v[122:123], v[4:5] op_sel:[0,1] op_sel_hi:[1,1]
v_pk_mul_f32 v[124:125], v[124:125], v[4:5] op_sel:[0,1] op_sel_hi:[1,1]
v_pk_mul_f32 v[126:127], v[126:127], v[4:5] op_sel:[0,1] op_sel_hi:[1,1]
s_mov_b64 exec, s[30:31]
s_cmp_lg_u32 s7, 0
s_cbranch_scc1 Lslow35
buffer_store_dwordx4 v[120:123], v6, s[44:47], s38 offen
buffer_store_dwordx4 v[124:127], v6, s[44:47], s11 offen
s_nop 1
Lback36:
s_mov_b64 exec, -1
v_lshlrev_b32 v123, 4, v0
s_cmp_eq_u32 s3, 3
s_cbranch_scc1 Lw337
buffer_load_dwordx4 v[64:67], v123, s[44:47], s39 offen sc1
buffer_load_dwordx4 v[72:75], v123, s[44:47], s86 offen sc1
buffer_load_dwordx4 v[80:83], v123, s[44:47], s88 offen sc1
buffer_load_dwordx4 v[68:71], v123, s[44:47], s85 offen sc1
buffer_load_dwordx4 v[76:79], v123, s[44:47], s87 offen sc1
buffer_load_dwordx4 v[84:87], v123, s[44:47], s12 offen sc1
s_barrier
s_lshl_b32 s9, s3, 5
v_xor_b32 v5, s9, v1
v_add_u32 v5, 131072, v5
ds_read_b64_tr_b16 v[40:41], v5 offset:0
ds_read_b64_tr_b16 v[42:43], v5 offset:512
ds_read_b64_tr_b16 v[44:45], v5 offset:4096
ds_read_b64_tr_b16 v[46:47], v5 offset:4608
ds_read_b64_tr_b16 v[48:49], v5 offset:8192
ds_read_b64_tr_b16 v[50:51], v5 offset:8704
ds_read_b64_tr_b16 v[52:53], v5 offset:12288
ds_read_b64_tr_b16 v[54:55], v5 offset:12800
ds_read_b64_tr_b16 v[56:57], v5 offset:16384
ds_read_b64_tr_b16 v[58:59], v5 offset:16896
ds_read_b64_tr_b16 v[60:61], v5 offset:20480
ds_read_b64_tr_b16 v[62:63], v5 offset:20992
v_and_b32 v6, 3, v0
v_mul_u32_u24 v120, 416, v6
v_lshrrev_b32 v6, 2, v0
v_lshl_add_u32 v120, v6, 3, v120
s_lshl_b32 s9, s3, 7
s_add_u32 s9, s9, 161984
v_add_u32 v120, s9, v120
v_and_b32 v121, 3, v0
v_mul_u32_u24 v121, 416, v121
v_lshrrev_b32 v4, 4, v0
v_lshl_add_u32 v121, v4, 4, v121
v_add_u32 v121, 161984, v121
v_and_b32 v122, 15, v0
v_lshlrev_b32 v122, 4, v122
v_lshrrev_b32 v4, 4, v0
v_lshl_add_u32 v122, v4, 6, v122
s_nop 1
Lc39:
s_waitcnt vmcnt(5)
v_max3_u32 v4, v64, v65, v66
s_waitcnt vmcnt(4)
v_max3_u32 v4, v4, v67, v72
v_max3_u32 v4, v4, v73, v74
s_waitcnt vmcnt(3)
v_max3_u32 v4, v4, v75, v80
v_max3_u32 v4, v4, v81, v82
v_max_u32 v4, v4, v83
v_pk_add_f32 v[88:89], v[64:65], v[72:73]
v_pk_add_f32 v[90:91], v[66:67], v[74:75]
v_pk_add_f32 v[88:89], v[88:89], v[80:81]
v_pk_add_f32 v[90:91], v[90:91], v[82:83]
v_mul_f32 v92, 0xbfb8aa3b, v88
v_mul_f32 v93, 0xbfb8aa3b, v89
v_mul_f32 v94, 0xbfb8aa3b, v90
v_mul_f32 v95, 0xbfb8aa3b, v91
v_exp_f32 v92, v92
v_exp_f32 v93, v93
v_exp_f32 v94, v94
v_exp_f32 v95, v95
v_pk_add_f32 v[92:93], v[92:93], 1.0 op_sel_hi:[1,0]
v_pk_add_f32 v[94:95], v[94:95], 1.0 op_sel_hi:[1,0]
v_rcp_f32 v92, v92
v_rcp_f32 v93, v93
v_rcp_f32 v94, v94
v_rcp_f32 v95, v95
s_waitcnt vmcnt(2)
v_max3_u32 v4, v4, v68, v69
v_max3_u32 v4, v4, v70, v71
s_waitcnt vmcnt(1)
v_max3_u32 v4, v4, v76, v77
v_max3_u32 v4, v4, v78, v79
s_waitcnt vmcnt(0)
v_max3_u32 v4, v4, v84, v85
v_max3_u32 v4, v4, v86, v87
v_cmp_eq_u32 vcc, -1, v4
s_cbranch_vccnz Lr40
Lo41:
v_pk_add_f32 v[96:97], v[68:69], v[76:77]
v_pk_add_f32 v[98:99], v[70:71], v[78:79]
v_pk_mul_f32 v[88:89], v[88:89], v[92:93]
v_pk_mul_f32 v[90:91], v[90:91], v[94:95]
v_pk_add_f32 v[96:97], v[96:97], v[84:85]
v_pk_add_f32 v[98:99], v[98:99], v[86:87]
v_pk_mul_f32 v[88:89], v[88:89], v[96:97]
v_pk_mul_f32 v[90:91], v[90:91], v[98:99]
v_cvt_pk_bf16_f32 v88, v88, v89
v_cvt_pk_bf16_f32 v89, v90, v91
ds_write_b64 v120, v[88:89]
s_nop 0
Lw3b38:
s_waitcnt lgkmcnt(0)
s_barrier
ds_read_b128 v[92:95], v121 offset:0
ds_read_b128 v[96:99], v121 offset:64
ds_read_b128 v[100:103], v121 offset:128
ds_read_b128 v[104:107], v121 offset:192
ds_read_b128 v[108:111], v121 offset:256
ds_read_b128 v[112:115], v121 offset:320
s_waitcnt lgkmcnt(5)
v_mfma_f32_16x16x32_bf16 v[116:119], v[40:43], v[92:95], 0
s_waitcnt lgkmcnt(4)
v_mfma_f32_16x16x32_bf16 v[116:119], v[44:47], v[96:99], v[116:119]
s_waitcnt lgkmcnt(3)
v_mfma_f32_16x16x32_bf16 v[116:119], v[48:51], v[100:103], v[116:119]
s_waitcnt lgkmcnt(2)
v_mfma_f32_16x16x32_bf16 v[116:119], v[52:55], v[104:107], v[116:119]
s_waitcnt lgkmcnt(1)
v_mfma_f32_16x16x32_bf16 v[116:119], v[56:59], v[108:111], v[116:119]
s_waitcnt lgkmcnt(0)
v_mfma_f32_16x16x32_bf16 v[116:119], v[60:63], v[112:115], v[116:119]
s_mov_b64 exec, s[30:31]
s_nop 6
buffer_store_dwordx4 v[116:119], v122, s[44:47], s0 offen sc1
s_cmp_lg_u32 s7, 0
s_cbranch_scc1 Lslow42
s_mov_b64 exec, 1
buffer_store_dword v0, v0, s[44:47], s99 offen
Lback43:
s_mov_b64 exec, -1
LnoS4531:
s_cmp_lg_u32 s6, 0
s_cbranch_scc1 LnoW744
s_cmp_ge_u32 s5, 24
s_cbranch_scc1 LnoW744
s_lshr_b32 s85, s5, 3
s_mul_i32 s85, s85, 1572864
s_lshl_b32 s9, s4, 10
s_add_u32 s85, s85, s9
s_and_b32 s9, s5, 7
s_lshl_b32 s9, s9, 7
s_add_u32 s85, s85, s9
v_lshrrev_b32 v5, 3, v0
v_and_b32 v6, 2, v5
v_xor_b32 v6, v6, v0
v_and_b32 v6, 7, v6
v_mul_u32_u24 v124, 8192, v5
v_lshl_add_u32 v124, v6, 4, v124
v_xor_b32 v125, 64, v124
s_mul_i32 s9, s3, 393216
s_add_u32 s9, s9, s85
s_mul_i32 s10, s3, 6144
s_add_u32 s10, s10, 131072
s_mov_b32 m0, s10
s_nop 0
buffer_load_dwordx4 v124, s[48:51], s9 offen  lds
s_add_u32 s9, s9, 65536
s_add_u32 s10, s10, 1024
s_mov_b32 m0, s10
s_nop 0
buffer_load_dwordx4 v125, s[48:51], s9 offen  lds
s_add_u32 s9, s9, 65536
s_add_u32 s10, s10, 1024
s_mov_b32 m0, s10
s_nop 0
buffer_load_dwordx4 v124, s[48:51], s9 offen  lds
s_add_u32 s9, s9, 65536
s_add_u32 s10, s10, 1024
s_mov_b32 m0, s10
s_nop 0
buffer_load_dwordx4 v125, s[48:51], s9 offen  lds
s_add_u32 s9, s9, 65536
s_add_u32 s10, s10, 1024
s_mov_b32 m0, s10
s_nop 0
buffer_load_dwordx4 v124, s[48:51], s9 offen  lds
s_add_u32 s9, s9, 65536
s_add_u32 s10, s10, 1024
s_mov_b32 m0, s10
s_nop 0
buffer_load_dwordx4 v125, s[48:51], s9 offen  lds
LnoW744:
s_cmp_lt_u32 s5, 23
s_cbranch_scc1 LnoR45
s_mul_i32 s9, s6, s4
s_cmp_lg_u32 s9, 0
s_cbranch_scc1 L_fin
s_sub_u32 s9, s5, 23
s_lshl_b32 s9, s9, 2
s_add_u32 s9, s9, s3
s_lshl_b32 s9, s9, 5
s_cmp_eq_u32 s6, 0
s_cselect_b32 s40, s44, s72
s_cselect_b32 s41, s45, s73
s_cselect_b32 s42, s46, s74
s_mov_b32 s43, 0x20000
s_cselect_b32 s70, s70, s9
s_cselect_b32 s71, s71, 0x7f000000
s_add_u32 s11, s1, 4096
v_lshlrev_b32 v38, 4, v0
v_and_b32 v39, 3, v0
v_lshlrev_b32 v37, 4, v39
v_bfe_u32 v4, v0, 3, 1
v_lshl_add_u32 v36, v4, 6, v37
v_bfe_u32 v4, v0, 2, 1
v_lshl_add_u32 v36, v4, 3, v36
v_lshrrev_b32 v4, 5, v0
v_lshl_add_u32 v37, v4, 2, v37
s_cmp_eq_u32 s6, 0
s_cbranch_scc1 L46
v_mul_u32_u24 v36, 1152, v39
v_bfe_u32 v4, v0, 2, 2
v_lshl_add_u32 v36, v4, 3, v36
s_nop 1
L46:
buffer_load_dwordx4 v[12:15], v38, s[44:47], s1 offen offset:0 sc1
buffer_load_dwordx4 v[16:19], v38, s[44:47], s1 offen offset:1024 sc1
buffer_load_dwordx4 v[20:23], v38, s[44:47], s1 offen offset:2048 sc1
buffer_load_dwordx4 v[24:27], v38, s[44:47], s1 offen offset:3072 sc1
buffer_load_dwordx4 v[28:31], v38, s[44:47], s11 offen offset:0 sc1
buffer_load_dwordx4 v[32:35], v38, s[44:47], s11 offen offset:1024 sc1
Lc47:
s_waitcnt vmcnt(5)
v_max3_u32 v4, v12, v13, v14
s_waitcnt vmcnt(4)
v_max3_u32 v4, v4, v15, v16
v_max3_u32 v4, v4, v17, v18
s_waitcnt vmcnt(3)
v_max3_u32 v4, v4, v19, v20
v_max3_u32 v4, v4, v21, v22
s_waitcnt vmcnt(2)
v_max3_u32 v4, v4, v23, v24
v_max3_u32 v4, v4, v25, v26
s_waitcnt vmcnt(1)
v_max3_u32 v4, v4, v27, v28
v_max3_u32 v4, v4, v29, v30
s_waitcnt vmcnt(0)
v_max3_u32 v4, v4, v31, v32
v_max3_u32 v4, v4, v33, v34
v_max_u32 v4, v4, v35
v_cmp_eq_u32 vcc, -1, v4
s_cbranch_vccnz Lr48
Lo49:
v_pk_add_f32 v[120:121], v[12:13], v[16:17]
v_pk_add_f32 v[122:123], v[14:15], v[18:19]
v_pk_add_f32 v[124:125], v[20:21], v[24:25]
v_pk_add_f32 v[126:127], v[22:23], v[26:27]
v_pk_add_f32 v[120:121], v[120:121], v[28:29]
v_pk_add_f32 v[122:123], v[122:123], v[30:31]
v_pk_add_f32 v[124:125], v[124:125], v[32:33]
v_pk_add_f32 v[126:127], v[126:127], v[34:35]
v_pk_add_f32 v[120:121], v[120:121], v[124:125]
v_pk_add_f32 v[122:123], v[122:123], v[126:127]
s_nop 1
v_permlane32_swap_b32 v120, v122
v_permlane32_swap_b32 v121, v123
v_pk_add_f32 v[120:121], v[120:121], v[122:123]
s_nop 1
v_permlane16_swap_b32 v120, v121
v_add_f32 v120, v120, v121
v_add_f32 v120, v120, v8
v_cvt_pk_bf16_f32 v120, v120, v120
v_and_b32 v8, 0xffff0000, v120
v_mov_b32 v121, v8
v_mov_b32 v122, v8
v_mov_b32 v126, v8
v_mul_f32 v127, v8, v8
v_permlane16_swap_b32 v121, v122
s_nop 0
v_permlane32_swap_b32 v126, v127
v_cvt_pk_bf16_f32 v124, v121, v122
v_add_f32 v126, v126, v127
v_mov_b32 v125, v124
s_nop 0
v_add_f32_dpp v126, v126, v126 row_ror:4 row_mask:0xf bank_mask:0xf
v_permlane32_swap_b32 v124, v125
s_nop 0
v_add_f32_dpp v126, v126, v126 row_ror:8 row_mask:0xf bank_mask:0xf
v_mov_b32 v127, v126
s_nop 1
v_permlane16_swap_b32 v126, v127
v_add_f32 v126, v126, v127
s_cmp_lg_u32 s7, 0
s_cbranch_scc1 Lslow50
s_mov_b64 exec, s[32:33]
buffer_store_dwordx2 v[124:125], v36, s[40:43], s70 offen
s_mov_b32 exec_lo, 15
s_mov_b32 exec_hi, 15
buffer_store_dword v126, v37, s[44:47], s71 offen
s_mov_b64 exec, -1
Lback51:
s_add_u32 s70, s70, 5888
s_add_u32 s71, s71, 5888
LnoR45:
s_cmp_lg_u32 s6, 0
s_cbranch_scc1 L_fin
s_add_u32 s37, s37, 65536
v_lshrrev_b32 v84, 2, v0
v_lshlrev_b32 v84, 8, v84
v_and_b32 v4, 3, v0
v_lshl_add_u32 v84, v4, 4, v84
s_cmp_ge_u32 s5, 24
s_cbranch_scc1 LnoS7r53
v_and_b32 v4, 15, v0
v_cmp_eq_u32 vcc, 4, v4
v_mov_b32 v4, 0x3f803f80
s_nop 0
v_cndmask_b32 v88, 0, v4, vcc
v_mov_b32 v89, v88
v_mov_b32 v90, v88
v_mov_b32 v91, v88
v_mov_b32 v92, v88
v_mov_b32 v93, v88
v_mov_b32 v94, v88
v_mov_b32 v95, v88
v_mov_b32 v96, v88
v_mov_b32 v97, v88
v_mov_b32 v98, v88
v_mov_b32 v99, v88
v_mov_b32 v100, v88
v_mov_b32 v101, v88
v_mov_b32 v102, v88
v_mov_b32 v103, v88
v_mov_b32 v104, v88
v_mov_b32 v105, v88
v_mov_b32 v106, v88
v_mov_b32 v107, v88
v_mov_b32 v108, v88
v_mov_b32 v109, v88
v_mov_b32 v110, v88
v_mov_b32 v111, v88
v_mov_b32 v116, 0
v_mov_b32 v117, 0
v_mov_b32 v118, 0
v_mov_b32 v119, 0
s_waitcnt vmcnt(0)
s_barrier
s_lshl_b32 s9, s3, 5
v_xor_b32 v5, s9, v1
v_add_u32 v5, 131072, v5
ds_read_b64_tr_b16 v[40:41], v5 offset:0
ds_read_b64_tr_b16 v[42:43], v5 offset:512
ds_read_b64_tr_b16 v[44:45], v5 offset:4096
ds_read_b64_tr_b16 v[46:47], v5 offset:4608
ds_read_b64_tr_b16 v[48:49], v5 offset:8192
ds_read_b64_tr_b16 v[50:51], v5 offset:8704
ds_read_b64_tr_b16 v[52:53], v5 offset:12288
ds_read_b64_tr_b16 v[54:55], v5 offset:12800
ds_read_b64_tr_b16 v[56:57], v5 offset:16384
ds_read_b64_tr_b16 v[58:59], v5 offset:16896
ds_read_b64_tr_b16 v[60:61], v5 offset:20480
ds_read_b64_tr_b16 v[62:63], v5 offset:20992
s_waitcnt lgkmcnt(0)
s_barrier
LnoS7r53:
s_mul_i32 s85, s84, 1769472
s_mul_i32 s9, s4, 1152
s_add_u32 s85, s85, s9
s_lshl_b32 s9, s83, 7
s_add_u32 s85, s85, s9
v_lshrrev_b32 v5, 3, v0
v_and_b32 v6, 2, v5
v_xor_b32 v6, v6, v0
v_and_b32 v6, 7, v6
v_mul_u32_u24 v124, 9216, v5
v_lshl_add_u32 v124, v6, 4, v124
v_xor_b32 v125, 64, v124
s_mul_i32 s9, s3, 442368
s_add_u32 s9, s9, s85
s_mul_i32 s10, s3, 6144
s_add_u32 s10, s10, 131072
s_mov_b32 m0, s10
s_nop 0
buffer_load_dwordx4 v124, s[56:59], s9 offen  lds
s_add_u32 s9, s9, 73728
s_add_u32 s10, s10, 1024
s_mov_b32 m0, s10
s_nop 0
buffer_load_dwordx4 v125, s[56:59], s9 offen  lds
s_add_u32 s9, s9, 73728
s_add_u32 s10, s10, 1024
s_mov_b32 m0, s10
s_nop 0
buffer_load_dwordx4 v124, s[56:59], s9 offen  lds
s_add_u32 s9, s9, 73728
s_add_u32 s10, s10, 1024
s_mov_b32 m0, s10
s_nop 0
buffer_load_dwordx4 v125, s[56:59], s9 offen  lds
s_add_u32 s9, s9, 73728
s_add_u32 s10, s10, 1024
s_mov_b32 m0, s10
s_nop 0
buffer_load_dwordx4 v124, s[56:59], s9 offen  lds
s_add_u32 s9, s9, 73728
s_add_u32 s10, s10, 1024
s_mov_b32 m0, s10
s_nop 0
buffer_load_dwordx4 v125, s[56:59], s9 offen  lds
s_cmp_ge_u32 s5, 24
s_cbranch_scc1 LnoS752
v_and_b32 v80, 15, v0
v_lshlrev_b32 v80, 6, v80
v_lshrrev_b32 v4, 4, v0
v_lshl_add_u32 v80, v4, 4, v80
v_and_b32 v6, 15, v0
v_lshlrev_b32 v6, 4, v6
v_lshrrev_b32 v4, 4, v0
v_lshl_add_u32 v6, v4, 6, v6
v_lshlrev_b32 v5, 4, v0
s_mov_b64 exec, 0xff
buffer_load_dwordx4 v[116:119], v5, s[44:47], s37 offen offset:1024 sc1
s_mov_b64 exec, -1
buffer_load_dwordx4 v[112:115], v5, s[44:47], s37 offen sc1
s_mov_b64 exec, s[30:31]
buffer_load_dwordx4 v[88:91], v6, s[44:47], s92 offen offset:0 sc1
buffer_load_dwordx4 v[92:95], v6, s[44:47], s92 offen offset:256 sc1
buffer_load_dwordx4 v[96:99], v6, s[44:47], s92 offen offset:512 sc1
buffer_load_dwordx4 v[100:103], v6, s[44:47], s92 offen offset:768 sc1
buffer_load_dwordx4 v[104:107], v6, s[44:47], s92 offen offset:1024 sc1
buffer_load_dwordx4 v[108:111], v6, s[44:47], s92 offen offset:1280 sc1
s_mov_b64 exec, -1
Lc54:
s_waitcnt vmcnt(7)
v_max3_u32 v4, v116, v117, v118
s_waitcnt vmcnt(6)
v_max3_u32 v4, v4, v119, v112
v_max3_u32 v4, v4, v113, v114
s_waitcnt vmcnt(5)
v_max3_u32 v4, v4, v115, v88
v_max3_u32 v4, v4, v89, v90
s_waitcnt vmcnt(4)
v_max3_u32 v4, v4, v91, v92
v_max3_u32 v4, v4, v93, v94
s_waitcnt vmcnt(3)
v_max3_u32 v4, v4, v95, v96
v_max3_u32 v4, v4, v97, v98
s_waitcnt vmcnt(2)
v_max3_u32 v4, v4, v99, v100
v_max3_u32 v4, v4, v101, v102
s_waitcnt vmcnt(1)
v_max3_u32 v4, v4, v103, v104
v_max3_u32 v4, v4, v105, v106
s_waitcnt vmcnt(0)
v_max3_u32 v4, v4, v107, v108
v_max3_u32 v4, v4, v109, v110
v_max_u32 v4, v4, v111
v_cmp_eq_u32 vcc, -1, v4
s_cbranch_vccnz Lr55
Lo56:
v_mfma_f32_16x16x32_bf16 v[120:123], v[40:43], v[88:91], 0
v_add_f32 v4, v112, v114
v_mfma_f32_16x16x32_bf16 v[120:123], v[44:47], v[92:95], v[120:123]
v_add_f32 v5, v113, v115
v_add_f32 v4, v4, v116
v_mfma_f32_16x16x32_bf16 v[120:123], v[48:51], v[96:99], v[120:123]
v_add_f32 v5, v5, v117
v_add_f32 v4, v4, v118
v_mfma_f32_16x16x32_bf16 v[120:123], v[52:55], v[100:103], v[120:123]
v_add_f32 v5, v5, v119
v_mfma_f32_16x16x32_bf16 v[120:123], v[56:59], v[104:107], v[120:123]
s_nop 0
v_permlane32_swap_b32 v4, v5
v_add_f32 v4, v4, v5
v_mfma_f32_16x16x32_bf16 v[120:123], v[60:63], v[108:111], v[120:123]
s_nop 0
v_add_f32_dpp v4, v4, v4 row_ror:4 row_mask:0xf bank_mask:0xf
s_nop 1
v_add_f32_dpp v4, v4, v4 row_ror:8 row_mask:0xf bank_mask:0xf
v_mov_b32 v5, v4
s_nop 1
v_permlane16_swap_b32 v4, v5
v_add_f32 v4, v4, v5
v_mov_b32 v5, v4
s_nop 1
v_permlane32_swap_b32 v4, v5
v_mul_f32 v4, 0xbae38e39, v4
v_mul_f32 v5, 0x3ae38e39, v5
v_fma_f32 v5, -v4, v4, v5
v_max_f32 v5, 0, v5
v_add_f32 v5, 0x3727c5ac, v5
v_rsq_f32 v5, v5
v_fmac_f32_dpp v120, v120, v4 row_newbcast:4 row_mask:0xf bank_mask:0xf
v_fmac_f32_dpp v121, v121, v4 row_newbcast:4 row_mask:0xf bank_mask:0xf
v_fmac_f32_dpp v122, v122, v4 row_newbcast:4 row_mask:0xf bank_mask:0xf
v_fmac_f32_dpp v123, v123, v4 row_newbcast:4 row_mask:0xf bank_mask:0xf
v_pk_mul_f32 v[120:121], v[120:121], v[4:5] op_sel:[0,1] op_sel_hi:[1,1]
v_pk_mul_f32 v[122:123], v[122:123], v[4:5] op_sel:[0,1] op_sel_hi:[1,1]
s_mov_b64 exec, s[30:31]
s_cmp_lg_u32 s7, 0
s_cbranch_scc1 Lslow57
buffer_store_dwordx4 v[120:123], v80, s[44:47], s93 offen
s_nop 1
Lback58:
s_mov_b64 exec, -1
LnoS752:
buffer_load_dwordx4 v[40:43], v84, s[44:47], s89 offen sc1
buffer_load_dwordx4 v[44:47], v84, s[44:47], s90 offen sc1
buffer_load_dwordx4 v[48:51], v84, s[44:47], s91 offen sc1
s_mul_i32 s9, s3, 576
s_add_u32 s9, s9, 160000
v_lshrrev_b32 v85, 5, v0
v_mul_u32_u24 v85, 288, v85
v_and_b32 v5, 31, v0
v_lshl_add_u32 v85, v5, 3, v85
v_add_u32 v85, s9, v85
v_and_b32 v5, 1, v0
v_mul_u32_u24 v5, 288, v5
v_lshrrev_b32 v6, 4, v0
v_lshl_add_u32 v6, v6, 4, v5
v_add_u32 v6, s9, v6
v_mov_b32 v52, 0
v_mov_b32 v53, 0
v_mov_b32 v54, 0
v_mov_b32 v55, 0
v_mov_b32 v56, 0
v_mov_b32 v57, 0
v_mov_b32 v58, 0
v_mov_b32 v59, 0
v_mov_b32 v60, 0
v_mov_b32 v61, 0
v_mov_b32 v62, 0
v_mov_b32 v63, 0
v_mov_b32 v64, 0
v_mov_b32 v65, 0
v_mov_b32 v66, 0
v_mov_b32 v67, 0
v_mov_b32 v68, 0
v_mov_b32 v69, 0
v_mov_b32 v70, 0
v_mov_b32 v71, 0
s_mov_b32 s6, 1
s_add_u32 s52, s52, 65536
s_add_u32 s53, s53, 65536
s_add_u32 s54, s54, 65536
s_add_u32 s55, s55, 65536
s_add_u32 s68, s68, 376832
s_add_u32 s69, s69, 376832
s_add_u32 s38, s38, 55296
s_add_u32 s39, s39, 55296
s_add_u32 s0, s0, 376832
s_add_u32 s1, s1, 376832
s_add_u32 s36, s36, 71424
s_add_u32 s37, s37, 5888
s_add_u32 s98, s98, 206592
s_add_u32 s99, s99, 206592
Lc59:
s_waitcnt vmcnt(2)
v_max3_u32 v4, v40, v41, v42
s_waitcnt vmcnt(1)
v_max3_u32 v4, v4, v43, v44
v_max3_u32 v4, v4, v45, v46
s_waitcnt vmcnt(0)
v_max3_u32 v4, v4, v47, v48
v_max3_u32 v4, v4, v49, v50
v_max_u32 v4, v4, v51
v_cmp_eq_u32 vcc, -1, v4
s_cbranch_vccnz Lr60
Lo61:
v_pk_add_f32 v[104:105], v[40:41], v[44:45]
v_pk_add_f32 v[106:107], v[42:43], v[46:47]
v_pk_add_f32 v[104:105], v[104:105], v[48:49]
v_pk_add_f32 v[106:107], v[106:107], v[50:51]
v_cvt_pk_bf16_f32 v104, v104, v105
v_cvt_pk_bf16_f32 v105, v106, v107
ds_write_b64 v85, v[104:105]
s_branch L_pair
LnoS213:
s_cmp_ge_u32 s5, 27
s_cbranch_scc1 Lpf62
s_waitcnt vmcnt(2)
s_barrier
s_lshl_b32 s9, s3, 5
v_xor_b32 v5, s9, v1
v_add_u32 v5, 131072, v5
ds_read_b64_tr_b16 v[40:41], v5 offset:0
ds_read_b64_tr_b16 v[42:43], v5 offset:512
ds_read_b64_tr_b16 v[44:45], v5 offset:4096
ds_read_b64_tr_b16 v[46:47], v5 offset:4608
ds_read_b64_tr_b16 v[48:49], v5 offset:8192
ds_read_b64_tr_b16 v[50:51], v5 offset:8704
ds_read_b64_tr_b16 v[52:53], v5 offset:12288
ds_read_b64_tr_b16 v[54:55], v5 offset:12800
ds_read_b64_tr_b16 v[56:57], v5 offset:16384
ds_read_b64_tr_b16 v[58:59], v5 offset:16896
ds_read_b64_tr_b16 v[60:61], v5 offset:20480
ds_read_b64_tr_b16 v[62:63], v5 offset:20992
s_mul_i32 s85, s84, 1769472
s_mul_i32 s9, s4, 1152
s_add_u32 s85, s85, s9
s_lshl_b32 s9, s83, 7
s_add_u32 s85, s85, s9
s_branch LnoS2b14
Lpf62:
s_cmp_lg_u32 s6, 0
s_cbranch_scc1 LnoM20
v_mov_b32 v72, -1
v_mov_b32 v73, -1
v_mov_b32 v74, -1
v_mov_b32 v75, -1
s_sub_u32 s9, s5, 27
s_lshl_b32 s9, s9, 2
s_add_u32 s9, s9, s3
s_mul_i32 s10, s4, 20
s_add_u32 s10, s10, s9
s_mul_i32 s10, s10, 2304
s_add_u32 s10, s10, 2473984
s_mul_i32 s9, s9, 9216
s_add_u32 s9, s9, s13
s_add_u32 s9, s9, 65536
buffer_store_dwordx4 v[72:75], v5, s[44:47], s9 offen offset:0 sc1
buffer_store_dwordx4 v[72:75], v5, s[44:47], s9 offen offset:1024 sc1
buffer_store_dwordx4 v[72:75], v5, s[44:47], s9 offen offset:2048 sc1
buffer_store_dwordx4 v[72:75], v5, s[44:47], s9 offen offset:3072 sc1
s_add_u32 s9, s9, 4096
buffer_store_dwordx4 v[72:75], v5, s[44:47], s9 offen offset:0 sc1
buffer_store_dwordx4 v[72:75], v5, s[44:47], s9 offen offset:1024 sc1
buffer_store_dwordx4 v[72:75], v5, s[44:47], s9 offen offset:2048 sc1
buffer_store_dwordx4 v[72:75], v5, s[44:47], s9 offen offset:3072 sc1
s_add_u32 s9, s9, 4096
buffer_store_dwordx4 v[72:75], v5, s[44:47], s9 offen offset:0 sc1
buffer_store_dwordx4 v[72:75], v5, s[44:47], s10 offen offset:0 sc1
buffer_store_dwordx4 v[72:75], v5, s[44:47], s10 offen offset:1024 sc1
s_mov_b64 exec, s[32:33]
buffer_store_dwordx4 v[72:75], v5, s[44:47], s10 offen offset:2048 sc1
s_mov_b64 exec, -1
s_branch LnoM20
Lw337:
s_barrier
s_lshl_b32 s9, s3, 5
v_xor_b32 v5, s9, v1
v_add_u32 v5, 131072, v5
ds_read_b64_tr_b16 v[40:41], v5 offset:0
ds_read_b64_tr_b16 v[42:43], v5 offset:512
ds_read_b64_tr_b16 v[44:45], v5 offset:4096
ds_read_b64_tr_b16 v[46:47], v5 offset:4608
ds_read_b64_tr_b16 v[48:49], v5 offset:8192
ds_read_b64_tr_b16 v[50:51], v5 offset:8704
ds_read_b64_tr_b16 v[52:53], v5 offset:12288
ds_read_b64_tr_b16 v[54:55], v5 offset:12800
ds_read_b64_tr_b16 v[56:57], v5 offset:16384
ds_read_b64_tr_b16 v[58:59], v5 offset:16896
ds_read_b64_tr_b16 v[60:61], v5 offset:20480
ds_read_b64_tr_b16 v[62:63], v5 offset:20992
v_and_b32 v6, 3, v0
v_mul_u32_u24 v120, 416, v6
v_lshrrev_b32 v6, 2, v0
v_lshl_add_u32 v120, v6, 3, v120
s_lshl_b32 s9, s3, 7
s_add_u32 s9, s9, 161984
v_add_u32 v120, s9, v120
v_and_b32 v121, 3, v0
v_mul_u32_u24 v121, 416, v121
v_lshrrev_b32 v4, 4, v0
v_lshl_add_u32 v121, v4, 4, v121
v_add_u32 v121, 161984, v121
v_and_b32 v122, 15, v0
v_lshlrev_b32 v122, 4, v122
v_lshrrev_b32 v4, 4, v0
v_lshl_add_u32 v122, v4, 6, v122
s_waitcnt vmcnt(0)
s_branch Lw3b38
L_fin:
s_endpgm
Lslow11:
buffer_store_dword v86, v126, s[44:47], s52 offen sc1
s_mov_b64 exec, 1
buffer_store_dwordx2 v[84:85], v127, s[44:47], s53 offen sc1
s_mov_b64 exec, -1
s_branch Lback12
Lslow18:
s_mov_b64 exec, 1
buffer_store_dword v0, v0, s[44:47], s98 offen sc1
s_branch Lback19
Lslow29:
s_mov_b64 exec, s[32:33]
buffer_store_dwordx2 v[124:125], v36, s[44:47], s70 offen sc1
s_mov_b32 exec_lo, 15
s_mov_b32 exec_hi, 15
buffer_store_dword v126, v37, s[44:47], s71 offen sc1
s_mov_b64 exec, -1
s_branch Lback30
Lslow35:
buffer_store_dwordx4 v[120:123], v6, s[44:47], s38 offen sc1
buffer_store_dwordx4 v[124:127], v6, s[44:47], s11 offen sc1
s_nop 0
s_branch Lback36
Lslow42:
s_mov_b64 exec, 1
buffer_store_dword v0, v0, s[44:47], s99 offen sc1
s_branch Lback43
Lslow50:
s_mov_b64 exec, s[32:33]
buffer_store_dwordx2 v[124:125], v36, s[40:43], s70 offen sc1
s_mov_b32 exec_lo, 15
s_mov_b32 exec_hi, 15
buffer_store_dword v126, v37, s[44:47], s71 offen sc1
s_mov_b64 exec, -1
s_branch Lback51
Lslow57:
buffer_store_dwordx4 v[120:123], v80, s[44:47], s93 offen sc1
s_nop 0
s_branch Lback58
Lr16:
s_add_u32 s8, s8, 1
s_cmp_gt_u32 s8, 200000
s_cbranch_scc1 Lo17
buffer_load_dwordx4 v[64:67], v6, s[44:47], s55 offen sc1
buffer_load_dwordx4 v[68:71], v6, s[44:47], s55 offen offset:16 sc1
buffer_load_dwordx4 v[72:75], v5, s[44:47], s54 offen offset:0 sc1
buffer_load_dwordx4 v[76:79], v5, s[44:47], s54 offen offset:1024 sc1
buffer_load_dwordx4 v[80:83], v5, s[44:47], s54 offen offset:2048 sc1
buffer_load_dwordx4 v[84:87], v5, s[44:47], s54 offen offset:3072 sc1
s_branch Lc15
Lr24:
s_add_u32 s8, s8, 1
s_cmp_gt_u32 s8, 200000
s_cbranch_scc1 Lo25
s_mov_b64 exec, 0x3ffff
buffer_load_dwordx4 v[12:15], v38, s[44:47], s12 offen sc1
s_mov_b64 exec, -1
s_branch Lc23
Lr27:
s_add_u32 s8, s8, 1
s_cmp_gt_u32 s8, 200000
s_cbranch_scc1 Lo28
buffer_load_dwordx4 v[12:15], v38, s[44:47], s69 offen offset:0 sc1
buffer_load_dwordx4 v[16:19], v38, s[44:47], s69 offen offset:1024 sc1
buffer_load_dwordx4 v[20:23], v38, s[44:47], s69 offen offset:2048 sc1
buffer_load_dwordx4 v[24:27], v38, s[44:47], s69 offen offset:3072 sc1
s_branch Lc26
Lr33:
s_add_u32 s8, s8, 1
s_cmp_gt_u32 s8, 200000
s_cbranch_scc1 Lo34
s_mov_b64 exec, 0xff
buffer_load_dwordx4 v[116:119], v5, s[44:47], s37 offen offset:1024 sc1
s_mov_b64 exec, -1
buffer_load_dwordx4 v[112:115], v5, s[44:47], s37 offen sc1
s_mov_b64 exec, s[30:31]
buffer_load_dwordx4 v[88:91], v6, s[44:47], s36 offen offset:0 sc1
buffer_load_dwordx4 v[92:95], v6, s[44:47], s36 offen offset:256 sc1
buffer_load_dwordx4 v[96:99], v6, s[44:47], s36 offen offset:512 sc1
buffer_load_dwordx4 v[100:103], v6, s[44:47], s36 offen offset:768 sc1
buffer_load_dwordx4 v[104:107], v6, s[44:47], s36 offen offset:1024 sc1
buffer_load_dwordx4 v[108:111], v6, s[44:47], s36 offen offset:1280 sc1
s_mov_b64 exec, -1
s_branch Lc32
Lr40:
s_add_u32 s8, s8, 1
s_cmp_gt_u32 s8, 200000
s_cbranch_scc1 Lo41
buffer_load_dwordx4 v[64:67], v123, s[44:47], s39 offen sc1
buffer_load_dwordx4 v[72:75], v123, s[44:47], s86 offen sc1
buffer_load_dwordx4 v[80:83], v123, s[44:47], s88 offen sc1
buffer_load_dwordx4 v[68:71], v123, s[44:47], s85 offen sc1
buffer_load_dwordx4 v[76:79], v123, s[44:47], s87 offen sc1
buffer_load_dwordx4 v[84:87], v123, s[44:47], s12 offen sc1
s_branch Lc39
Lr48:
s_add_u32 s8, s8, 1
s_cmp_gt_u32 s8, 200000
s_cbranch_scc1 Lo49
buffer_load_dwordx4 v[12:15], v38, s[44:47], s1 offen offset:0 sc1
buffer_load_dwordx4 v[16:19], v38, s[44:47], s1 offen offset:1024 sc1
buffer_load_dwordx4 v[20:23], v38, s[44:47], s1 offen offset:2048 sc1
buffer_load_dwordx4 v[24:27], v38, s[44:47], s1 offen offset:3072 sc1
buffer_load_dwordx4 v[28:31], v38, s[44:47], s11 offen offset:0 sc1
buffer_load_dwordx4 v[32:35], v38, s[44:47], s11 offen offset:1024 sc1
s_branch Lc47
Lr55:
s_add_u32 s8, s8, 1
s_cmp_gt_u32 s8, 200000
s_cbranch_scc1 Lo56
s_mov_b64 exec, 0xff
buffer_load_dwordx4 v[116:119], v5, s[44:47], s37 offen offset:1024 sc1
s_mov_b64 exec, -1
buffer_load_dwordx4 v[112:115], v5, s[44:47], s37 offen sc1
s_mov_b64 exec, s[30:31]
buffer_load_dwordx4 v[88:91], v6, s[44:47], s92 offen offset:0 sc1
buffer_load_dwordx4 v[92:95], v6, s[44:47], s92 offen offset:256 sc1
buffer_load_dwordx4 v[96:99], v6, s[44:47], s92 offen offset:512 sc1
buffer_load_dwordx4 v[100:103], v6, s[44:47], s92 offen offset:768 sc1
buffer_load_dwordx4 v[104:107], v6, s[44:47], s92 offen offset:1024 sc1
buffer_load_dwordx4 v[108:111], v6, s[44:47], s92 offen offset:1280 sc1
s_mov_b64 exec, -1
s_branch Lc54
Lr60:
s_add_u32 s8, s8, 1
s_cmp_gt_u32 s8, 200000
s_cbranch_scc1 Lo61
buffer_load_dwordx4 v[40:43], v84, s[44:47], s89 offen sc1
buffer_load_dwordx4 v[44:47], v84, s[44:47], s90 offen sc1
buffer_load_dwordx4 v[48:51], v84, s[44:47], s91 offen sc1
s_branch Lc59
L_end:
s_endpgm
.section .rodata,"a"
.p2align 6
.amdhsa_kernel interleave_layers__gqa_block_cached__glu_gated_swiglu__decode_kernel
.amdhsa_next_free_vgpr 512
.amdhsa_next_free_sgpr 102
.amdhsa_accum_offset 256
.amdhsa_group_segment_fixed_size 0
.amdhsa_kernarg_size 96
.amdhsa_user_sgpr_count 2
.amdhsa_user_sgpr_kernarg_segment_ptr 1
.amdhsa_system_sgpr_workgroup_id_x 1
.end_amdhsa_kernel
```
